```python
import torch

def _softmax(x, axis=-1):
    return torch.softmax(x, dim=axis)
def _gelu(x):
    return torch.nn.functional.gelu(x, approximate="tanh")
def _silu(x):
    return torch.nn.functional.silu(x)
def _sigmoid(x):
    return torch.sigmoid(x)
def _layernorm(x, axis=-1, eps=1e-5):
    m = x.mean(dim=axis, keepdim=True)
    v = x.var(dim=axis, keepdim=True, unbiased=False)
    return (x - m) / torch.sqrt(v + eps)
def _scatter_add(tgt, idx, src, axis=0):
    return tgt.clone().index_add_(axis, idx, src)
def _segment_sum(src, seg, n):
    out = torch.zeros((n,) + src.shape[1:], dtype=src.dtype)
    return out.index_add_(0, seg, src)
def _pad(x, pw):
    flat = tuple(v for pair in reversed(pw) for v in pair)
    return torch.nn.functional.pad(x, flat)

kernel_name = 'standalone__edge_featured_mpnn_mpnn__graph'

def setup_inputs():

    _w = (lambda a: (lambda t: t.to(torch.bfloat16) if t.is_floating_point() else t)(torch.as_tensor(a)))
    N, deg, D, De = 12500, 64, 64, max(0, 1)
    E = N * deg
    H = 2 * D
    return {
        "x": _w((lambda *s: torch.randn(*s, dtype=torch.bfloat16) * 0.05)(N, D)),
        "e_attr": _w((lambda *s: torch.randn(*s, dtype=torch.bfloat16) * 1.6)(E, De)),
        "src": _w((lambda lo, hi, *s: torch.randint(lo, hi, s))(0, N, E).to(torch.int64)),
        "dst": _w((lambda lo, hi, *s: torch.randint(lo, hi, s))(0, N, E).to(torch.int64)),
        "w1": _w((lambda *s: torch.randn(*s, dtype=torch.bfloat16) * 1.6)(2 * D + De, H) * (1.0 / (2 * D + De) ** 0.5)),
        "b1": _w((lambda *s: torch.randn(*s, dtype=torch.bfloat16) * 1.6)(H) * 0.01),
        "w2": _w((lambda *s: torch.randn(*s, dtype=torch.bfloat16) * 0.05)(H, D) * (1.0 / H ** 0.5)),
        "b2": _w((lambda *s: torch.randn(*s, dtype=torch.bfloat16) * 0.05)(D) * 0.01),
    }

def reference(x, e_attr, src, dst, w1, b1, w2, b2):
    N, D = x.shape
    h_src = x[src]
    h_dst = x[dst]
    m_in = torch.concatenate([h_src, h_dst, e_attr], axis=-1)
    h = _silu(m_in @ w1 + b1)
    msg = h @ w2 + b2
    return _segment_sum(msg, dst, N)
```

```asm
; @launch grid=(256,1,1) block=(768,1,1) lds=151296
.amdgcn_target "amdgcn-amd-amdhsa--gfx950"
.text
.p2align 8
.globl standalone__edge_featured_mpnn_mpnn__graph_kernel
.type standalone__edge_featured_mpnn_mpnn__graph_kernel,@function
standalone__edge_featured_mpnn_mpnn__graph_kernel:
    s_cmp_ge_u32 s2, 256
    s_cbranch_scc1 K_end
    s_load_dwordx8 s[4:11], s[0:1], 0
    s_load_dwordx8 s[12:19], s[0:1], 32
    s_load_dwordx4 s[20:23], s[0:1], 64
    s_load_dwordx2 s[24:25], s[0:1], 80
    s_memrealtime s[64:65]
    s_getpc_b64 s[34:35]
    s_lshr_b32 s3, s2, 3
    s_lshl_b32 s3, s3, 7
    v_lshl_add_u32 v2, v0, 12, s3
    v_cmp_gt_u32 vcc, 7, v0
    s_and_saveexec_b64 s[32:33], vcc
    s_cbranch_execz K_ncp
    global_load_dword v5, v2, s[34:35]
K_ncp:
    s_mov_b64 exec, s[32:33]
    v_lshrrev_b32 v1, 6, v0
    v_mov_b32 v155, v0
    v_readfirstlane_b32 s29, v1
    v_and_b32 v154, 63, v0
    s_mul_i32 s3, s2, 12288
    v_lshl_add_u32 v13, v0, 4, s3
    v_lshrrev_b32 v25, 1, v13
    s_and_b32 s26, s2, 7
    s_lshl_b32 s26, s26, 5
    s_lshr_b32 s3, s2, 3
    s_add_u32 s26, s26, s3
    s_mul_i32 s27, s26, 49
    s_sub_u32 s28, 12500, s27
    s_min_u32 s28, s28, 49
    v_and_b32 v156, 31, v0
    v_bfe_u32 v157, v0, 5, 1
    s_mov_b32 s30, 0
    v_mov_b32 v128, 0
    v_mov_b32 v129, 0
    v_mov_b32 v130, 0
    v_mov_b32 v131, 0
    v_lshlrev_b32 v160, 2, v0
    s_waitcnt lgkmcnt(0)
    global_load_dwordx4 v[0:3], v13, s[10:11]
    ds_write_b32 v160, v128 offset:48896
    s_cmp_lg_u32 s29, 11
    s_cbranch_scc1 K_ld1
    s_mul_i32 s60, s2, 53
    s_add_u32 s60, s60, 786432
    v_min_u32 v163, 52, v154
    v_add_lshl_u32 v163, v163, s60, 2
    v_lshrrev_b32 v162, 1, v163
    global_load_dword v4, v163, s[10:11]
    global_load_dword v12, v163, s[8:9]
    global_load_ushort v16, v162, s[6:7]
K_ld1:
    s_lshl_b32 s60, s2, 4
    s_add_u32 s60, s60, s29
    s_cmp_lg_u32 s60, 9
    s_cbranch_scc1 K_ldJ
    s_lshl_b32 s60, s64, 25
    s_or_b32 s60, s60, 1
    s_lshr_b64 s[64:65], s[64:65], 7
    v_mov_b32 v162, s60
    v_mov_b32 v163, s64
    s_mov_b64 exec, 1
    global_store_dwordx2 v128, v[162:163], s[22:23] sc1
    s_mov_b64 exec, -1
K_ldJ:
    s_lshl_b32 s60, s29, 11
    s_cmp_ge_u32 s29, 8
    s_cbranch_scc1 K_stX
    s_add_u32 m0, s60, 85504
    v_lshrrev_b32 v161, 2, v154
    v_and_b32 v161, 12, v161
    v_xor_b32 v161, v161, v154
    v_lshl_add_u32 v163, v161, 4, s60
    global_load_lds_dwordx4 v163, s[12:13]
    global_load_lds_dwordx4 v163, s[12:13] offset:1024
    s_branch K_stJ
K_stX:
    s_mov_b32 s36, s4
    s_mov_b32 s37, s5
    s_mov_b32 s38, 1600000
    s_mov_b32 s39, 0x00020000
    s_add_u32 m0, s60, 118272
    s_lshl_b32 s61, s27, 7
    s_add_u32 s60, s60, s61
    s_sub_u32 s60, s60, 16384
    v_lshrrev_b32 v161, 4, v154
    v_xor_b32 v161, v161, v154
    v_lshl_add_u32 v161, v161, 4, s60
    v_xor_b32 v163, 64, v161
    buffer_load_dwordx4 v161, s[36:39], 0 offen  lds
    buffer_load_dwordx4 v163, s[36:39], 0 offen offset:1024  lds
K_stJ:
    s_waitcnt lgkmcnt(0)
    s_barrier
    v_mov_b32 v56, 16383
    v_mov_b32 v57, 16383
    v_mov_b32 v58, 16383
    v_mov_b32 v59, 16383
    v_lshlrev_b32 v160, 4, v155
    ds_write_b128 v160, v[56:59] offset:18176
    s_cmp_ge_u32 s29, 4
    s_cbranch_scc1 K_in1
    ds_write_b128 v160, v[128:131]
    ds_write_b128 v160, v[56:59] offset:28160
K_in1:
    s_cmp_lg_u32 s29, 4
    s_cbranch_scc1 K_in2
    v_lshlrev_b32 v161, 2, v154
    ds_write_b32 v161, v128 offset:17920
K_in2:
    global_load_dwordx4 v[8:11], v13, s[8:9]
    global_load_dwordx2 v[14:15], v25, s[6:7]
    v_mov_b32 v6, v163
    s_lshr_b32 s60, s2, 3
    s_mul_i32 s60, s60, 12
    s_add_u32 s60, s60, s29
    s_add_u32 s61, s60, 128
    s_mov_b64 s[34:35], s[12:13]
    s_sub_u32 s60, s60, 130
    s_cbranch_scc1 K_wp
    s_mov_b32 s61, s60
    s_mov_b64 s[34:35], s[16:17]
    s_sub_u32 s60, s60, 128
    s_cbranch_scc1 K_wp
    s_and_b32 s61, s60, 1
    s_mov_b64 s[34:35], s[14:15]
    s_cmp_lt_u32 s60, 2
    s_cbranch_scc1 K_wp
    s_mov_b32 s61, 0
    s_mov_b64 s[34:35], s[18:19]
K_wp:
    s_lshl_b32 s61, s61, 7
    v_mov_b32 v7, s61
    global_load_dword v5, v7, s[34:35]
    v_and_b32 v37, 3, v154
    v_lshlrev_b32 v37, 3, v37
    v_and_b32 v159, 16, v154
    v_lshl_add_u32 v37, v159, 1, v37
    s_lshr_b32 s63, s29, 1
    v_bfe_u32 v158, v154, 2, 2
    v_xor_b32 v161, s63, v158
    v_lshlrev_b32 v161, 6, v161
    v_lshl_add_u32 v158, v157, 3, v158
    v_lshl_add_u32 v158, v158, 8, v161
    v_add_u32 v38, 85504, v158
    v_and_b32 v31, 1, v154
    v_lshl_add_u32 v31, v31, 5, v38
    v_and_b32 v161, 16, v154
    v_add_u32 v31, v31, v161
    v_and_b32 v161, 2, v154
    v_lshl_add_u32 v31, v161, 2, v31
    s_and_b32 s60, s29, 1
    s_lshl_b32 s60, s60, 12
    s_add_u32 s60, s60, 134656
    v_bfe_u32 v161, v154, 1, 3
    v_xor_b32 v161, v161, v157
    v_lshl_add_u32 v161, v161, 4, s60
    v_lshl_add_u32 v88, v156, 7, v161
    v_xor_b32 v89, 32, v88
    v_xor_b32 v90, 64, v88
    v_xor_b32 v91, 0x60, v88
    s_mov_b32 s60, 21400
    s_mov_b32 s61, -49
    s_mov_b32 s62, 0xffff0000
    v_mov_b32 v163, 0x10004
    v_mov_b32 v24, 0
    v_mov_b32 v125, 0x4000
    s_waitcnt vmcnt(5)
    s_cmp_lg_u32 s29, 11
    s_cbranch_scc1 K_wJ
    s_bfm_b64 exec, 53, 0
    v_mul_u32_u24 v24, s60, v4
    v_lshrrev_b32 v24, 18, v24
    v_and_b32 v24, 0x3fc, v24
    ds_add_rtn_u32 v30, v24, v163 offset:48896
    v_lshlrev_b32 v4, 2, v4
    v_mad_i32_i24 v4, v24, s61, v4
    v_bfe_u32 v124, v4, 2, 1
    s_mov_b64 exec, -1
K_wJ:
    v_mul_u32_u24 v20, s60, v0
    v_mul_u32_u24 v21, s60, v1
    v_mul_u32_u24 v22, s60, v2
    v_mul_u32_u24 v23, s60, v3
    v_lshrrev_b32 v20, 18, v20
    v_lshrrev_b32 v21, 18, v21
    v_lshrrev_b32 v22, 18, v22
    v_lshrrev_b32 v23, 18, v23
    v_and_b32 v20, 0x3fc, v20
    ds_add_rtn_u32 v26, v20, v163 offset:48896
    v_and_b32 v21, 0x3fc, v21
    ds_add_rtn_u32 v27, v21, v163 offset:48896
    v_and_b32 v22, 0x3fc, v22
    ds_add_rtn_u32 v28, v22, v163 offset:48896
    v_and_b32 v23, 0x3fc, v23
    ds_add_rtn_u32 v29, v23, v163 offset:48896
    v_lshlrev_b32 v0, 2, v0
    v_lshlrev_b32 v1, 2, v1
    v_lshlrev_b32 v2, 2, v2
    v_lshlrev_b32 v3, 2, v3
    v_mad_i32_i24 v0, v20, s61, v0
    v_mad_i32_i24 v1, v21, s61, v1
    v_mad_i32_i24 v2, v22, s61, v2
    v_mad_i32_i24 v3, v23, s61, v3
    v_bfe_u32 v120, v0, 2, 1
    v_bfe_u32 v121, v1, 2, 1
    v_bfe_u32 v122, v2, 2, 1
    v_bfe_u32 v123, v3, 2, 1
    s_waitcnt vmcnt(3) lgkmcnt(0)
    s_barrier
    s_cmp_eq_u32 s29, 8
    s_cbranch_scc1 K_scan1
    s_cmp_gt_u32 s29, 8
    s_cbranch_scc1 K_notP
    ds_read_b128 v[40:43], v88
    ds_read_b64_tr_b16 v[56:57], v31 offset:0
    ds_read_b64_tr_b16 v[58:59], v31 offset:1024
    ds_read_b128 v[44:47], v89
    ds_read_b64_tr_b16 v[60:61], v31 offset:4096
    ds_read_b64_tr_b16 v[62:63], v31 offset:5120
    ds_read_b128 v[48:51], v90
    ds_read_b64_tr_b16 v[64:65], v31 offset:8192
    ds_read_b64_tr_b16 v[66:67], v31 offset:9216
    ds_read_b128 v[52:55], v91
    ds_read_b64_tr_b16 v[68:69], v31 offset:12288
    ds_read_b64_tr_b16 v[70:71], v31 offset:13312
    s_waitcnt lgkmcnt(9)
    v_mfma_f32_32x32x16_bf16 v[72:87], v[56:59], v[40:43], 0
    s_waitcnt lgkmcnt(6)
    v_mfma_f32_32x32x16_bf16 v[72:87], v[60:63], v[44:47], v[72:87]
    s_waitcnt lgkmcnt(3)
    v_mfma_f32_32x32x16_bf16 v[72:87], v[64:67], v[48:51], v[72:87]
    s_waitcnt lgkmcnt(0)
    v_mfma_f32_32x32x16_bf16 v[72:87], v[68:71], v[52:55], v[72:87]
    s_and_b32 s61, s29, 1
    s_mul_i32 s60, s61, 8704
    s_lshl_b32 s61, s63, 6
    s_add_u32 s60, s60, s61
    s_add_u32 s60, s60, 118784
    v_mul_u32_u24 v161, 272, v156
    v_lshl_add_u32 v161, v157, 5, v161
    v_add_u32 v161, s60, v161
    v_mov_b32 v162, 0xbfb8aa3b
    v_cmp_gt_u32 vcc, 134016, v161
    s_nop 1
    v_pk_mul_f32 v[72:73], v[72:73], v[162:163] op_sel_hi:[1,0]
    v_pk_mul_f32 v[74:75], v[74:75], v[162:163] op_sel_hi:[1,0]
    v_pk_mul_f32 v[76:77], v[76:77], v[162:163] op_sel_hi:[1,0]
    v_pk_mul_f32 v[78:79], v[78:79], v[162:163] op_sel_hi:[1,0]
    v_pk_mul_f32 v[80:81], v[80:81], v[162:163] op_sel_hi:[1,0]
    v_pk_mul_f32 v[82:83], v[82:83], v[162:163] op_sel_hi:[1,0]
    v_pk_mul_f32 v[84:85], v[84:85], v[162:163] op_sel_hi:[1,0]
    v_pk_mul_f32 v[86:87], v[86:87], v[162:163] op_sel_hi:[1,0]
    v_cvt_pk_bf16_f32 v72, v72, v73
    v_cvt_pk_bf16_f32 v73, v74, v75
    v_cvt_pk_bf16_f32 v74, v76, v77
    v_cvt_pk_bf16_f32 v75, v78, v79
    v_cvt_pk_bf16_f32 v76, v80, v81
    v_cvt_pk_bf16_f32 v77, v82, v83
    v_cvt_pk_bf16_f32 v78, v84, v85
    v_cvt_pk_bf16_f32 v79, v86, v87
    s_mov_b64 exec, vcc
    ds_write_b128 v161, v[72:75]
    ds_write_b128 v161, v[76:79] offset:16
    s_mov_b64 exec, -1
    s_branch K_b3
K_notP:
    v_lshlrev_b32 v159, 4, v154
    v_add_u32 v162, 131840, v159
    v_add_u32 v159, 12288, v159
    s_branch K_b3
K_scan1:
    s_setprio 2
    global_load_dwordx2 v[18:19], v128, s[22:23]
    v_lshlrev_b32 v158, 4, v154
    ds_read_b128 v[56:59], v158 offset:48896
    s_waitcnt lgkmcnt(0)
    v_lshrrev_b32 v60, 16, v56
    v_lshrrev_b32 v61, 16, v57
    v_lshrrev_b32 v62, 16, v58
    v_lshrrev_b32 v63, 16, v59
    v_mad_u32_u24 v64, v60, 5, 3
    v_mad_u32_u24 v65, v61, 5, 3
    v_mad_u32_u24 v66, v62, 5, 3
    v_mad_u32_u24 v67, v63, 5, 3
    v_and_b32 v64, -4, v64
    v_and_b32 v65, -4, v65
    v_and_b32 v66, -4, v66
    v_and_b32 v67, -4, v67
    v_add_u32 v65, v64, v65
    v_add_u32 v66, v65, v66
    v_add_u32 v67, v66, v67
    v_mov_b32 v68, v67
    s_nop 1
    v_add_u32_dpp v68, v68, v68 row_shr:1 row_mask:0xf bank_mask:0xf
    s_nop 1
    v_add_u32_dpp v68, v68, v68 row_shr:2 row_mask:0xf bank_mask:0xf
    s_nop 1
    v_add_u32_dpp v68, v68, v68 row_shr:4 row_mask:0xf bank_mask:0xf
    s_nop 1
    v_add_u32_dpp v68, v68, v68 row_shr:8 row_mask:0xf bank_mask:0xf
    s_nop 1
    v_add_u32_dpp v68, v68, v68 row_bcast:15 row_mask:0xa bank_mask:0xf
    s_nop 1
    v_add_u32_dpp v68, v68, v68 row_bcast:31 row_mask:0xc bank_mask:0xf
    v_sub_u32 v68, v68, v67
    v_add_u32 v69, v68, v64
    v_add_u32 v70, v68, v65
    v_add_u32 v71, v68, v66
    s_mov_b32 s60, 0x10001
    v_mul_u32_u24 v64, s60, v68
    v_mul_u32_u24 v65, s60, v69
    v_mul_u32_u24 v66, s60, v70
    v_mul_u32_u24 v67, s60, v71
    v_lshl_add_u32 v64, v56, 16, v64
    v_lshl_add_u32 v65, v57, 16, v65
    v_lshl_add_u32 v66, v58, 16, v66
    v_lshl_add_u32 v67, v59, 16, v67
    ds_write_b128 v158, v[64:67] offset:49920
    s_setprio 0
K_b3:
    v_lshrrev_b32 v158, 4, v155
    v_lshl_add_u32 v158, v158, 4, v160
    v_add_u32 v158, 118784, v158
    s_lshl_b32 s60, s27, 8
    s_add_u32 s60, s60, 4980736
    s_add_u32 s40, s24, s60
    s_addc_u32 s41, s25, 0
    s_lshl_b32 s42, s28, 8
    s_mov_b32 s43, 0x00020000
    s_waitcnt lgkmcnt(0)
    s_barrier
    s_cmp_lt_u32 s29, 10
    s_cbranch_scc1 K_nx0
    ds_read_b32 v36, v24 offset:49920
    ds_read_b128 v[76:79], v162
K_nx0:
    ds_read_b128 v[72:75], v158
    ds_read_b32 v32, v20 offset:49920
    ds_read_b32 v33, v21 offset:49920
    ds_read_b32 v34, v22 offset:49920
    ds_read_b32 v35, v23 offset:49920
    s_waitcnt lgkmcnt(4)
    buffer_store_dwordx4 v[72:75], v160, s[40:43], 0 offen sc1
    s_waitcnt vmcnt(3)
    s_cmp_eq_u32 s29, 8
    s_cbranch_scc1 K_w8
    s_waitcnt vmcnt(2)
K_w8:
    v_lshl_or_b32 v8, v125, v120, v8
    v_lshl_or_b32 v9, v125, v121, v9
    v_lshl_or_b32 v10, v125, v122, v10
    v_lshl_or_b32 v11, v125, v123, v11
    v_lshl_or_b32 v8, v14, 16, v8
    v_and_or_b32 v9, v14, s62, v9
    v_lshl_or_b32 v10, v15, 16, v10
    v_and_or_b32 v11, v15, s62, v11
    s_waitcnt lgkmcnt(0)
    v_add_u32_sdwa v20, v32, v26 dst_sel:DWORD dst_unused:UNUSED_PAD src0_sel:WORD_0 src1_sel:WORD_0
    v_add_u32_sdwa v32, v32, v26 dst_sel:DWORD dst_unused:UNUSED_PAD src0_sel:WORD_1 src1_sel:WORD_1
    ds_write_b32 v20, v8 offset:32256
    ds_write_b8 v32, v0 offset:32256
    v_add_u32_sdwa v21, v33, v27 dst_sel:DWORD dst_unused:UNUSED_PAD src0_sel:WORD_0 src1_sel:WORD_0
    v_add_u32_sdwa v33, v33, v27 dst_sel:DWORD dst_unused:UNUSED_PAD src0_sel:WORD_1 src1_sel:WORD_1
    ds_write_b32 v21, v9 offset:32256
    ds_write_b8 v33, v1 offset:32256
    v_add_u32_sdwa v22, v34, v28 dst_sel:DWORD dst_unused:UNUSED_PAD src0_sel:WORD_0 src1_sel:WORD_0
    v_add_u32_sdwa v34, v34, v28 dst_sel:DWORD dst_unused:UNUSED_PAD src0_sel:WORD_1 src1_sel:WORD_1
    ds_write_b32 v22, v10 offset:32256
    ds_write_b8 v34, v2 offset:32256
    v_add_u32_sdwa v23, v35, v29 dst_sel:DWORD dst_unused:UNUSED_PAD src0_sel:WORD_0 src1_sel:WORD_0
    v_add_u32_sdwa v35, v35, v29 dst_sel:DWORD dst_unused:UNUSED_PAD src0_sel:WORD_1 src1_sel:WORD_1
    ds_write_b32 v23, v11 offset:32256
    ds_write_b8 v35, v3 offset:32256
    s_cmp_lt_u32 s29, 10
    s_cbranch_scc1 K_nx2
    s_cmp_eq_u32 s29, 11
    s_cbranch_scc1 K_x2
    buffer_store_dwordx4 v[76:79], v159, s[40:43], 0 offen sc1
    s_branch K_nx2
K_x2:
    s_bfm_b64 exec, 53, 0
    v_lshl_or_b32 v12, v125, v124, v12
    v_lshl_or_b32 v12, v16, 16, v12
    v_add_u32_sdwa v24, v36, v30 dst_sel:DWORD dst_unused:UNUSED_PAD src0_sel:WORD_0 src1_sel:WORD_0
    v_add_u32_sdwa v36, v36, v30 dst_sel:DWORD dst_unused:UNUSED_PAD src0_sel:WORD_1 src1_sel:WORD_1
    ds_write_b32 v24, v12 offset:32256
    ds_write_b8 v36, v4 offset:32256
    s_mov_b64 exec, -1
K_nx2:
    s_cmp_ge_u32 s29, 8
    s_cbranch_scc1 K_st2
    s_add_u32 m0, m0, 16384
    v_add_u32 v6, 0x4000, v6
    global_load_lds_dwordx4 v6, s[12:13]
    global_load_lds_dwordx4 v6, s[12:13] offset:1024
    s_branch K_st3
K_st2:
    s_mov_b32 m0, 118272
    v_lshlrev_b32 v161, 2, v154
    v_add_u32 v7, 0x8000, v161
    global_load_lds_dword v7, s[12:13]
    s_mov_b32 m0, 118528
    s_nop 0
    global_load_lds_dword v161, s[14:15]
K_st3:
    s_mul_i32 s60, s2, 16640
    s_add_u32 s44, s24, s60
    s_addc_u32 s45, s25, 0
    s_mov_b32 s46, 16512
    s_mov_b32 s47, 0x00020000
    v_add_u32 v161, 12288, v160
    s_waitcnt lgkmcnt(0)
    s_barrier
    ds_read_b128 v[0:3], v160 offset:32256
    s_cmp_ge_u32 s29, 5
    s_cbranch_scc1 K_co1
    ds_read_b128 v[8:11], v160 offset:44544
    s_waitcnt lgkmcnt(0)
    buffer_store_dwordx4 v[8:11], v161, s[44:47], 0 offen sc1
K_co1:
    s_waitcnt lgkmcnt(0)
    buffer_store_dwordx4 v[0:3], v160, s[44:47], 0 offen sc1
    v_and_b32 v17, 15, v154
    v_bfe_u32 v161, v154, 4, 1
    v_lshlrev_b32 v161, 2, v161
    v_xor_b32 v17, v17, v161
    v_lshlrev_b32 v133, 4, v17
    v_mov_b32 v135, v133
    v_mov_b32 v137, v133
    v_mov_b32 v139, v133
    v_lshrrev_b32 v141, 4, v154
    v_lshlrev_b32 v141, 1, v141
    v_bfe_u32 v17, v154, 3, 1
    v_xor_b32 v161, v17, v157
    v_lshl_add_u32 v161, v161, 6, v37
    v_lshl_add_u32 v17, v17, 8, v161
    s_lshl_b32 s61, s29, 12
    s_add_u32 s61, s61, 85504
    v_add_u32 v17, s61, v17
    v_bfe_u32 v162, v154, 2, 1
    v_cmp_ne_u32 vcc, 0, v162
    v_mov_b32 v161, 128
    v_mov_b32 v146, 1.0
    v_cndmask_b32 v140, v161, v17, vcc
    v_cmp_eq_u32 s[66:67], v162, v157
    v_bfe_u32 v17, v154, 3, 2
    v_and_b32 v161, 3, v154
    v_lshl_add_u32 v17, v17, 2, v161
    v_lshlrev_b32 v17, 2, v17
    v_add_u32 v17, 4096, v17
    v_mov_b32 v161, 3952
    v_cndmask_b32 v142, v161, v17, s[66:67]
    v_mov_b32 v161, 0x80
    v_cndmask_b32 v144, 0, v161, s[66:67]
    v_and_b32 v114, 1, v154
    v_mul_u32_u24 v114, 8640, v114
    v_add_u32 v114, 32, v114
    s_movk_i32 s48, 3072
    s_movk_i32 s49, 2048
    s_movk_i32 s50, 1024
    s_movk_i32 s51, 0
    v_mov_b32 v102, 0
    v_mov_b32 v103, 0
    v_mov_b32 v104, 1.0
    v_mov_b32 v105, 1.0
    v_mov_b32 v106, 0
    v_mov_b32 v107, 0
    v_mov_b32 v108, 1.0
    v_mov_b32 v109, 1.0
    s_and_b32 s60, s29, 3
    s_mul_i32 s60, s60, 3
    s_lshr_b32 s61, s29, 2
    s_add_u32 s59, s60, s61
    s_getpc_b64 s[32:33]
K_pc:
    s_add_u32 s32, s32, K_vbase - K_pc
    s_addc_u32 s33, s33, 0
    v_mul_u32_u24 v17, 10923, v155
    v_lshrrev_b32 v17, 16, v17
    v_mad_i32_i24 v164, v17, -6, v155
    v_lshlrev_b32 v164, 2, v164
    v_mul_u32_u24 v165, 16640, v17
    s_lshr_b32 s60, s2, 3
    s_mul_i32 s60, s60, 99968
    s_add_u32 s60, s60, 4980736
    v_lshl_add_u32 v126, v155, 7, s60
    s_lshr_b32 s61, s26, 2
    s_lshl_b32 s61, s61, 4
    s_and_b32 s60, s26, 1
    s_lshl_b32 s60, s60, 3
    s_add_u32 s61, s61, s60
    s_and_b32 s60, s26, 2
    s_lshl_b32 s60, s60, 9
    s_add_u32 s61, s61, s60
    s_add_u32 s61, s61, 4325376
    v_lshl_add_u32 v163, v17, 11, s61
    s_mov_b32 s3, 0xbfb8aa3b
    s_cmp_lg_u32 s29, 8
    s_cbranch_scc1 K_ntb
    s_mov_b32 s31, 0
    s_waitcnt vmcnt(4)
K_tagp:
    v_cmp_ne_u32 vcc, 0, v18
    s_cbranch_vccnz K_tagok
    s_add_u32 s31, s31, 1
    s_cmp_gt_u32 s31, 4000
    s_cbranch_scc1 K_tagok
    global_load_dwordx2 v[18:19], v128, s[22:23] sc1
    s_waitcnt vmcnt(0)
    s_branch K_tagp
K_tagok:
    ds_write_b64 v128, v[18:19] offset:544
    v_and_b32 v161, 0xfe000000, v18
    s_lshl_b32 s61, s2, 11
    s_add_u32 s61, s61, 4325376
    v_lshl_add_u32 v159, v154, 4, s61
    v_lshrrev_b32 v68, 2, v68
    v_lshl_or_b32 v68, v60, 13, v68
    v_or_b32 v88, v161, v68
    v_mov_b32 v89, v19
    v_lshrrev_b32 v69, 2, v69
    v_lshl_or_b32 v69, v61, 13, v69
    v_or_b32 v90, v161, v69
    v_mov_b32 v91, v19
    v_lshrrev_b32 v70, 2, v70
    v_lshl_or_b32 v70, v62, 13, v70
    v_or_b32 v92, v161, v70
    v_mov_b32 v93, v19
    v_lshrrev_b32 v71, 2, v71
    v_lshl_or_b32 v71, v63, 13, v71
    v_or_b32 v94, v161, v71
    v_mov_b32 v95, v19
    s_waitcnt vmcnt(0) lgkmcnt(0)
    s_barrier
    s_cbranch_vccz K_slow
    global_store_dwordx4 v159, v[88:91], s[24:25] sc1
    global_store_dwordx4 v159, v[92:95], s[24:25] offset:1024 sc1
    s_branch K_b5j
K_ntb:
    s_waitcnt vmcnt(0)
    s_barrier
K_b5j:
    ds_read_b64 v[18:19], v128 offset:544
    v_lshlrev_b32 v158, 1, v154
    v_add_u32 v158, 118272, v158
    ds_read_u16 v98, v158
    ds_read_u16 v100, v158 offset:128
    s_waitcnt lgkmcnt(0)
    v_readfirstlane_b32 s64, v18
    v_readfirstlane_b32 s65, v19
    s_cmp_eq_u32 s64, 0
    s_cbranch_scc1 K_slow
    v_lshlrev_b32 v98, 16, v98
    v_mul_f32 v98, s3, v98
    v_cvt_pk_bf16_f32 v161, v128, v98
    v_sub_f32 v161, v98, v161
    v_cvt_pk_bf16_f32 v99, v98, v161
    v_lshlrev_b32 v100, 16, v100
    v_mul_f32 v100, s3, v100
    v_cvt_pk_bf16_f32 v161, v128, v100
    v_sub_f32 v161, v100, v161
    v_cvt_pk_bf16_f32 v101, v100, v161
    s_cmp_lt_u32 s29, 8
    s_cbranch_scc1 K_Q
    s_sub_u32 s60, s29, 8
    s_lshl_b32 s60, s60, 12
    s_add_u32 m0, s60, 134656
    v_lshl_add_u32 v161, v154, 4, s60
    global_load_lds_dwordx4 v161, s[16:17]
    global_load_lds_dwordx4 v161, s[16:17] offset:1024
    global_load_lds_dwordx4 v161, s[16:17] offset:2048
    global_load_lds_dwordx4 v161, s[16:17] offset:3072
    s_cmp_lg_u32 s29, 9
    s_cbranch_scc1 K_notQ
    s_mov_b32 m0, 151040
    v_lshlrev_b32 v161, 2, v156
    global_load_lds_dword v161, s[18:19]
    s_branch K_notQ
K_Q:
    s_mov_b32 s3, 0xbf38aa3b
    s_lshl_b32 s60, s63, 6
    s_add_u32 s60, s60, 118528
    v_lshl_add_u32 v161, v156, 1, s60
    ds_read_u16 v96, v161
    v_add_u32 v17, v38, v37
    ds_read_b64_tr_b16 v[56:57], v17 offset:16384
    ds_read_b64_tr_b16 v[58:59], v17 offset:17408
    ds_read_b64_tr_b16 v[60:61], v17 offset:20480
    ds_read_b64_tr_b16 v[62:63], v17 offset:21504
    ds_read_b64_tr_b16 v[64:65], v17 offset:24576
    ds_read_b64_tr_b16 v[66:67], v17 offset:25600
    ds_read_b64_tr_b16 v[68:69], v17 offset:28672
    ds_read_b64_tr_b16 v[70:71], v17 offset:29696
    s_and_b32 s60, s29, 1
    s_lshl_b32 s61, s60, 14
    s_lshl_b32 s62, s63, 7
    s_add_u32 s61, s61, s62
    s_add_u32 s61, s61, 59904
    v_lshl_add_u32 v17, v157, 11, s61
    v_lshl_add_u32 v17, v156, 2, v17
    s_waitcnt lgkmcnt(6)
    v_mfma_f32_32x32x16_bf16 v[72:87], v[40:43], v[56:59], 0
    s_waitcnt lgkmcnt(4)
    v_mfma_f32_32x32x16_bf16 v[72:87], v[44:47], v[60:63], v[72:87]
    s_waitcnt lgkmcnt(2)
    v_mfma_f32_32x32x16_bf16 v[72:87], v[48:51], v[64:67], v[72:87]
    s_waitcnt lgkmcnt(0)
    v_mfma_f32_32x32x16_bf16 v[72:87], v[52:55], v[68:71], v[72:87]
    v_lshlrev_b32 v96, 16, v96
    v_mul_f32 v96, s3, v96
    s_nop 9
    v_fma_f32 v72, v72, s3, v96
    v_fma_f32 v73, v73, s3, v96
    v_cvt_pk_bf16_f32 v56, v72, v73
    ds_write_b32 v17, v56 offset:512
    ds_write_b16 v17, v56 offset:0
    ds_write_b16_d16_hi v17, v56 offset:1026
    v_fma_f32 v74, v74, s3, v96
    v_fma_f32 v75, v75, s3, v96
    v_cvt_pk_bf16_f32 v58, v74, v75
    ds_write_b32 v17, v58 offset:1536
    ds_write_b16 v17, v58 offset:1024
    ds_write_b16_d16_hi v17, v58 offset:2050
    v_fma_f32 v76, v76, s3, v96
    v_fma_f32 v77, v77, s3, v96
    v_cvt_pk_bf16_f32 v60, v76, v77
    ds_write_b32 v17, v60 offset:4608
    ds_write_b16 v17, v60 offset:4096
    ds_write_b16_d16_hi v17, v60 offset:5122
    v_fma_f32 v78, v78, s3, v96
    v_fma_f32 v79, v79, s3, v96
    v_cvt_pk_bf16_f32 v62, v78, v79
    ds_write_b32 v17, v62 offset:5632
    ds_write_b16 v17, v62 offset:5120
    ds_write_b16_d16_hi v17, v62 offset:6146
    v_fma_f32 v80, v80, s3, v96
    v_fma_f32 v81, v81, s3, v96
    v_cvt_pk_bf16_f32 v64, v80, v81
    ds_write_b32 v17, v64 offset:8704
    ds_write_b16 v17, v64 offset:8192
    ds_write_b16_d16_hi v17, v64 offset:9218
    v_fma_f32 v82, v82, s3, v96
    v_fma_f32 v83, v83, s3, v96
    v_cvt_pk_bf16_f32 v66, v82, v83
    ds_write_b32 v17, v66 offset:9728
    ds_write_b16 v17, v66 offset:9216
    ds_write_b16_d16_hi v17, v66 offset:10242
    s_cmp_eq_u32 s60, 1
    s_cbranch_scc1 K_notQ
    v_fma_f32 v84, v84, s3, v96
    v_fma_f32 v85, v85, s3, v96
    v_cvt_pk_bf16_f32 v68, v84, v85
    ds_write_b32 v17, v68 offset:12800
    ds_write_b16 v17, v68 offset:12288
    ds_write_b16_d16_hi v17, v68 offset:13314
    v_fma_f32 v86, v86, s3, v96
    v_fma_f32 v87, v87, s3, v96
    v_cvt_pk_bf16_f32 v70, v86, v87
    ds_write_b32 v17, v70 offset:13824
    ds_write_b16 v17, v70 offset:13312
    ds_write_b16_d16_hi v17, v70 offset:14338
K_notQ:
    s_waitcnt lgkmcnt(0)
    s_barrier
    s_lshl_b32 s61, s29, 12
    s_add_u32 m0, s61, 85504
    s_mov_b32 s44, s24
    s_mov_b32 s45, s25
    s_mov_b32 s46, 4849664
    s_mov_b32 s60, 262144
    s_mov_b32 s61, 2129920
    s_mov_b32 s62, 0xfe000000
    s_movk_i32 s63, 0xfc
    s_mov_b32 s31, 0
K_nls:
    s_mov_b64 s[66:67], -1
    s_mov_b64 s[68:69], -1
    v_mov_b32 v28, 0
    v_mov_b32 v29, 0
K_poll:
    s_mov_b64 exec, s[66:67]
    s_cbranch_execz K_pl0
    buffer_load_dwordx2 v[0:1], v163, s[44:47], 0 offen sc1
K_pl0:
    s_mov_b64 exec, s[68:69]
    s_cbranch_execz K_pl1
    buffer_load_dwordx2 v[2:3], v163, s[44:47], s60 offen sc1
K_pl1:
    s_mov_b64 exec, -1
    s_waitcnt vmcnt(0)
    v_xor_b32 v4, s64, v0
    v_xor_b32 v6, s65, v1
    v_and_or_b32 v6, v4, s62, v6
    v_cmp_ne_u32 s[66:67], 0, v6
    v_xor_b32 v5, s64, v2
    v_xor_b32 v7, s65, v3
    v_and_or_b32 v7, v5, s62, v7
    v_cmp_ne_u32 s[68:69], 0, v7
    s_add_u32 s31, s31, 1
    s_or_b64 vcc, s[66:67], s[68:69]
    s_cbranch_scc0 K_got
    s_cmp_lt_u32 s31, 4000
    s_cbranch_scc1 K_poll
    s_mov_b32 s30, 1
    s_branch K_nor2a
K_got:
    v_and_b32 v6, 0x1fff, v0
    v_bfe_u32 v1, v0, 13, 12
    v_lshl_add_u32 v6, v6, 2, v165
    v_sub_u32 v4, v1, v164
    v_lshl_add_u32 v8, v1, 2, v6
    v_cmp_lt_i32 s[66:67], 0, v4
    v_lshl_add_u32 v6, v164, 2, v6
    v_add_u32 v8, v8, v164
    s_or_b64 exec, s[66:67], 1
    buffer_load_dword v28, v8, s[44:47], 0 offen
    buffer_load_dwordx4 v[12:15], v6, s[44:47], 0 offen
    s_mov_b64 exec, -1
    v_and_b32 v7, 0x1fff, v2
    v_bfe_u32 v3, v2, 13, 12
    v_lshl_add_u32 v7, v7, 2, v165
    v_sub_u32 v5, v3, v164
    v_lshl_add_u32 v9, v3, 2, v7
    v_cmp_lt_i32 s[74:75], 0, v5
    v_lshl_add_u32 v7, v164, 2, v7
    v_add_u32 v9, v9, v164
    s_or_b64 exec, s[74:75], 1
    buffer_load_dword v29, v9, s[44:47], s61 offen
    buffer_load_dwordx4 v[16:19], v7, s[44:47], s61 offen
    s_mov_b64 exec, -1
    v_cmp_lt_i32 s[68:69], 1, v4
    v_cmp_lt_i32 s[70:71], 2, v4
    v_cmp_lt_i32 s[72:73], 3, v4
    v_cmp_lt_i32 s[76:77], 1, v5
    v_cmp_lt_i32 s[78:79], 2, v5
    v_cmp_lt_i32 s[80:81], 3, v5
    v_max_i32 v159, v4, v5
    v_cmp_lt_i32 vcc, 24, v159
    s_mov_b32 s31, 0
    s_cbranch_vccz K_nor2a
    s_mov_b32 s31, 1
    buffer_load_dword v30, v8, s[44:47], 0 offen offset:24
    buffer_load_dwordx4 v[20:23], v6, s[44:47], 0 offen offset:96
    v_cmp_lt_i32 s[82:83], 24, v4
    v_cmp_lt_i32 s[84:85], 25, v4
    v_cmp_lt_i32 s[86:87], 26, v4
    v_cmp_lt_i32 s[88:89], 27, v4
    buffer_load_dword v31, v9, s[44:47], s61 offen offset:24
    buffer_load_dwordx4 v[24:27], v7, s[44:47], s61 offen offset:96
    v_cmp_lt_i32 s[90:91], 24, v5
    v_cmp_lt_i32 s[92:93], 25, v5
    v_cmp_lt_i32 s[94:95], 26, v5
    v_cmp_lt_i32 s[96:97], 27, v5
    v_cmp_lt_i32 vcc, 48, v159
    s_cbranch_vccz K_nor2a
    s_mov_b32 s30, 1
K_nor2a:
    v_mov_b32 v162, 536
    v_mov_b32 v158, 4
    s_cmp_eq_u32 s30, 0
    s_cbranch_scc1 K_nofl
    ds_write_b32 v162, v158
K_nofl:
    s_waitcnt lgkmcnt(0)
    s_barrier
    ds_read_b32 v161, v162
    s_add_u32 s36, s24, 4977664
    s_addc_u32 s37, s25, 0
    s_and_b32 s37, s37, 0xffff
    s_or_b32 s37, s37, 0x01000000
    s_mov_b32 s38, 12500
    s_mov_b32 s39, 0x00020000
    s_waitcnt lgkmcnt(0)
    v_cmp_ne_u32 vcc, 0, v161
    s_cbranch_vccnz K_slow
    s_cmp_lt_u32 s29, 8
    s_cbranch_scc1 K_npf
    global_load_dword v163, v126, s[24:25] sc1
    s_waitcnt vmcnt(1)
    s_branch K_pfJ
K_npf:
    v_and_b32 v72, 7, v154
    v_lshlrev_b32 v74, 4, v72
    v_add_u32 v74, 151040, v74
    ds_read_b128 v[76:79], v74
    v_and_b32 v125, -8, v155
    v_lshlrev_b32 v127, 4, v155
    v_lshlrev_b32 v72, 5, v72
    v_add_u32 v124, 60416, v72
    s_waitcnt lgkmcnt(0)
    v_lshlrev_b32 v128, 16, v76
    v_and_b32 v129, 0xffff0000, v76
    v_lshlrev_b32 v130, 16, v77
    v_and_b32 v131, 0xffff0000, v77
    v_lshlrev_b32 v122, 16, v78
    v_and_b32 v123, 0xffff0000, v78
    v_lshlrev_b32 v152, 16, v79
    v_and_b32 v153, 0xffff0000, v79
    s_cmp_ge_u32 s29, 4
    s_cbranch_scc1 K_np1
    v_bfe_u32 v70, v154, 2, 1
    v_bfe_u32 v71, v154, 3, 1
    v_lshl_add_u32 v70, v70, 6, v71
    v_lshrrev_b32 v71, 4, v154
    v_lshl_add_u32 v70, v71, 2, v70
    v_lshlrev_b32 v70, 7, v70
    v_and_b32 v72, 3, v154
    v_lshl_add_u32 v70, v72, 4, v70
    v_add_u32 v147, 134656, v70
    v_and_b32 v70, 15, v154
    s_lshl_b32 s62, s29, 4
    v_add_u32 v70, s62, v70
    v_mul_u32_u24 v72, 288, v70
    v_lshl_add_u32 v72, v71, 4, v72
    v_add_u32 v164, 32256, v72
    v_mul_u32_u24 v72, 272, v70
    v_lshl_add_u32 v72, v71, 5, v72
    v_add_u32 v165, 60416, v72
K_np1:
    s_waitcnt vmcnt(0)
K_pfJ:
    v_and_b32_sdwa v32, v28, s63 dst_sel:DWORD dst_unused:UNUSED_PAD src0_sel:BYTE_0 src1_sel:DWORD
    v_and_b32_sdwa v33, v28, s63 dst_sel:DWORD dst_unused:UNUSED_PAD src0_sel:BYTE_1 src1_sel:DWORD
    v_and_b32_sdwa v34, v28, s63 dst_sel:DWORD dst_unused:UNUSED_PAD src0_sel:BYTE_2 src1_sel:DWORD
    v_and_b32_sdwa v35, v28, s63 dst_sel:DWORD dst_unused:UNUSED_PAD src0_sel:BYTE_3 src1_sel:DWORD
    v_and_b32_sdwa v36, v29, s63 dst_sel:DWORD dst_unused:UNUSED_PAD src0_sel:BYTE_0 src1_sel:DWORD
    v_and_b32_sdwa v37, v29, s63 dst_sel:DWORD dst_unused:UNUSED_PAD src0_sel:BYTE_1 src1_sel:DWORD
    v_and_b32_sdwa v38, v29, s63 dst_sel:DWORD dst_unused:UNUSED_PAD src0_sel:BYTE_2 src1_sel:DWORD
    v_and_b32_sdwa v39, v29, s63 dst_sel:DWORD dst_unused:UNUSED_PAD src0_sel:BYTE_3 src1_sel:DWORD
    s_mov_b64 exec, s[66:67]
    ds_add_rtn_u32 v48, v32, v158 offset:272
    s_mov_b64 exec, s[68:69]
    ds_add_rtn_u32 v49, v33, v158 offset:272
    s_mov_b64 exec, s[70:71]
    ds_add_rtn_u32 v50, v34, v158 offset:272
    s_mov_b64 exec, s[72:73]
    ds_add_rtn_u32 v51, v35, v158 offset:272
    s_mov_b64 exec, s[74:75]
    ds_add_rtn_u32 v52, v36, v158 offset:272
    s_mov_b64 exec, s[76:77]
    ds_add_rtn_u32 v53, v37, v158 offset:272
    s_mov_b64 exec, s[78:79]
    ds_add_rtn_u32 v54, v38, v158 offset:272
    s_mov_b64 exec, s[80:81]
    ds_add_rtn_u32 v55, v39, v158 offset:272
    s_mov_b64 exec, -1
    s_cmp_eq_u32 s31, 0
    s_cbranch_scc1 K_nor2b
    v_and_b32_sdwa v40, v30, s63 dst_sel:DWORD dst_unused:UNUSED_PAD src0_sel:BYTE_0 src1_sel:DWORD
    v_and_b32_sdwa v41, v30, s63 dst_sel:DWORD dst_unused:UNUSED_PAD src0_sel:BYTE_1 src1_sel:DWORD
    v_and_b32_sdwa v42, v30, s63 dst_sel:DWORD dst_unused:UNUSED_PAD src0_sel:BYTE_2 src1_sel:DWORD
    v_and_b32_sdwa v43, v30, s63 dst_sel:DWORD dst_unused:UNUSED_PAD src0_sel:BYTE_3 src1_sel:DWORD
    v_and_b32_sdwa v44, v31, s63 dst_sel:DWORD dst_unused:UNUSED_PAD src0_sel:BYTE_0 src1_sel:DWORD
    v_and_b32_sdwa v45, v31, s63 dst_sel:DWORD dst_unused:UNUSED_PAD src0_sel:BYTE_1 src1_sel:DWORD
    v_and_b32_sdwa v46, v31, s63 dst_sel:DWORD dst_unused:UNUSED_PAD src0_sel:BYTE_2 src1_sel:DWORD
    v_and_b32_sdwa v47, v31, s63 dst_sel:DWORD dst_unused:UNUSED_PAD src0_sel:BYTE_3 src1_sel:DWORD
    s_mov_b64 exec, s[82:83]
    ds_add_rtn_u32 v56, v40, v158 offset:272
    s_mov_b64 exec, s[84:85]
    ds_add_rtn_u32 v57, v41, v158 offset:272
    s_mov_b64 exec, s[86:87]
    ds_add_rtn_u32 v58, v42, v158 offset:272
    s_mov_b64 exec, s[88:89]
    ds_add_rtn_u32 v59, v43, v158 offset:272
    s_mov_b64 exec, s[90:91]
    ds_add_rtn_u32 v60, v44, v158 offset:272
    s_mov_b64 exec, s[92:93]
    ds_add_rtn_u32 v61, v45, v158 offset:272
    s_mov_b64 exec, s[94:95]
    ds_add_rtn_u32 v62, v46, v158 offset:272
    s_mov_b64 exec, s[96:97]
    ds_add_rtn_u32 v63, v47, v158 offset:272
    s_mov_b64 exec, -1
K_nor2b:
    v_lshlrev_b32 v159, 2, v154
    v_cmp_gt_u32 vcc, s28, v154
    s_waitcnt lgkmcnt(0)
    s_barrier
    ds_read_b32 v149, v159 offset:272
    s_waitcnt lgkmcnt(0)
    v_add_u32 v151, 4, v149
    v_and_b32 v151, -8, v151
    v_max_u32 v151, 64, v151
    v_cndmask_b32 v151, 0, v151, vcc
    v_mov_b32 v150, v151
    s_nop 1
    v_add_u32_dpp v150, v150, v150 row_shr:1 row_mask:0xf bank_mask:0xf
    s_nop 1
    v_add_u32_dpp v150, v150, v150 row_shr:2 row_mask:0xf bank_mask:0xf
    s_nop 1
    v_add_u32_dpp v150, v150, v150 row_shr:4 row_mask:0xf bank_mask:0xf
    s_nop 1
    v_add_u32_dpp v150, v150, v150 row_shr:8 row_mask:0xf bank_mask:0xf
    s_nop 1
    v_add_u32_dpp v150, v150, v150 row_bcast:15 row_mask:0xa bank_mask:0xf
    s_nop 1
    v_add_u32_dpp v150, v150, v150 row_bcast:31 row_mask:0xc bank_mask:0xf
    s_nop 0
    v_readlane_b32 s60, v150, 63
    v_sub_u32 v150, v150, v151
    ds_write_b32 v159, v150 offset:1296
    s_cmp_gt_u32 s60, 13888
    s_cbranch_scc1 K_slow
    ds_read_b32 v64, v32 offset:1296
    ds_read_b32 v65, v33 offset:1296
    ds_read_b32 v66, v34 offset:1296
    ds_read_b32 v67, v35 offset:1296
    ds_read_b32 v68, v36 offset:1296
    ds_read_b32 v69, v37 offset:1296
    ds_read_b32 v70, v38 offset:1296
    ds_read_b32 v71, v39 offset:1296
    s_add_u32 s60, s60, 63
    s_lshr_b32 s58, s60, 6
    s_mul_i32 s56, s59, s58
    s_add_u32 s57, s56, s58
    s_mul_i32 s56, s56, 43691
    s_mul_i32 s57, s57, 43691
    s_lshr_b32 s56, s56, 19
    s_lshr_b32 s57, s57, 19
    s_sub_u32 s57, s57, s56
    s_waitcnt lgkmcnt(6)
    v_add_u32 v48, v64, v48
    v_add_u32 v49, v65, v49
    s_waitcnt lgkmcnt(4)
    v_add_u32 v50, v66, v50
    v_add_u32 v51, v67, v51
    s_waitcnt lgkmcnt(2)
    v_add_u32 v52, v68, v52
    v_add_u32 v53, v69, v53
    s_waitcnt lgkmcnt(0)
    v_add_u32 v54, v70, v54
    v_add_u32 v55, v71, v55
    s_mov_b64 exec, s[66:67]
    ds_write_b32 v48, v12 offset:18176
    s_mov_b64 exec, s[68:69]
    ds_write_b32 v49, v13 offset:18176
    s_mov_b64 exec, s[70:71]
    ds_write_b32 v50, v14 offset:18176
    s_mov_b64 exec, s[72:73]
    ds_write_b32 v51, v15 offset:18176
    s_mov_b64 exec, s[74:75]
    ds_write_b32 v52, v16 offset:18176
    s_mov_b64 exec, s[76:77]
    ds_write_b32 v53, v17 offset:18176
    s_mov_b64 exec, s[78:79]
    ds_write_b32 v54, v18 offset:18176
    s_mov_b64 exec, s[80:81]
    ds_write_b32 v55, v19 offset:18176
    s_mov_b64 exec, -1
    s_cmp_eq_u32 s31, 0
    s_cbranch_scc1 K_nor2c
    s_waitcnt lgkmcnt(0)
    ds_read_b32 v72, v40 offset:1296
    ds_read_b32 v73, v41 offset:1296
    ds_read_b32 v74, v42 offset:1296
    ds_read_b32 v75, v43 offset:1296
    ds_read_b32 v76, v44 offset:1296
    ds_read_b32 v77, v45 offset:1296
    ds_read_b32 v78, v46 offset:1296
    ds_read_b32 v79, v47 offset:1296
    s_waitcnt lgkmcnt(6)
    v_add_u32 v56, v72, v56
    v_add_u32 v57, v73, v57
    s_waitcnt lgkmcnt(4)
    v_add_u32 v58, v74, v58
    v_add_u32 v59, v75, v59
    s_waitcnt lgkmcnt(2)
    v_add_u32 v60, v76, v60
    v_add_u32 v61, v77, v61
    s_waitcnt lgkmcnt(0)
    v_add_u32 v62, v78, v62
    v_add_u32 v63, v79, v63
    s_mov_b64 exec, s[82:83]
    ds_write_b32 v56, v20 offset:18176
    s_mov_b64 exec, s[84:85]
    ds_write_b32 v57, v21 offset:18176
    s_mov_b64 exec, s[86:87]
    ds_write_b32 v58, v22 offset:18176
    s_mov_b64 exec, s[88:89]
    ds_write_b32 v59, v23 offset:18176
    s_mov_b64 exec, s[90:91]
    ds_write_b32 v60, v24 offset:18176
    s_mov_b64 exec, s[92:93]
    ds_write_b32 v61, v25 offset:18176
    s_mov_b64 exec, s[94:95]
    ds_write_b32 v62, v26 offset:18176
    s_mov_b64 exec, s[96:97]
    ds_write_b32 v63, v27 offset:18176
    s_mov_b64 exec, -1
K_nor2c:
    s_lshl_b32 s60, s56, 6
    v_lshl_add_u32 v161, v141, 1, s60
    v_add_u32 v160, s60, v159
    v_cmp_ge_u32 s[66:67], s60, v150
    v_subrev_u32 v158, s60, v150
    s_and_b64 s[66:67], s[66:67], vcc
    s_bcnt1_i32_b64 s61, s[66:67]
    s_sub_u32 s61, s61, 1
    s_andn2_b64 s[66:67], vcc, s[66:67]
    v_bfe_u32 v162, v158, 3, 3
    v_add_u32 v162, 1, v162
    v_lshrrev_b32 v158, 4, v158
    v_min_u32 v158, 0xfc, v158
    v_cndmask_b32 v158, -4, v158, s[66:67]
    v_mov_b32 v80, 0
    ds_permute_b32 v80, v158, v162
    s_cmp_lg_u32 s29, 0
    s_cbranch_scc1 K_nprep
    v_cvt_f32_u32 v70, s58
    v_rcp_f32 v70, v70
    v_add3_u32 v151, v150, v151, -4
    v_lshrrev_b32 v150, 6, v150
    v_lshrrev_b32 v151, 6, v151
    v_cvt_f32_u32 v150, v150
    v_cvt_f32_u32 v151, v151
    v_add_f32 v150, 0x3f755555, v150
    v_add_f32 v151, 0x3f755555, v151
    v_mul_f32 v70, 0x41400000, v70
    v_mul_f32 v150, v150, v70
    v_mul_f32 v151, v151, v70
    v_cvt_u32_f32 v150, v150
    v_cvt_u32_f32 v151, v151
    v_cvt_f32_u32 v71, v149
    v_sub_u32 v151, v151, v150
    v_add_u32 v150, v150, v154
    v_mul_u32_u24 v150, 272, v150
    v_mul_f32 v71, 0x3e800000, v71
    v_lshl_or_b32 v70, v151, 16, v150
    v_lshlrev_b32 v72, 3, v154
    v_cndmask_b32 v70, 0, v70, vcc
    ds_write_b64 v72, v[70:71] offset:52224
K_nprep:
    s_waitcnt lgkmcnt(0)
    s_barrier
    ds_read_u16 v132, v161 offset:18176
    ds_read_u16 v134, v161 offset:18192
    ds_read_u16 v136, v161 offset:18208
    ds_read_u16 v138, v161 offset:18224
    ds_read_b32 v82, v160 offset:18176
    ds_read_b32 v83, v160 offset:18432
    ds_read_b32 v84, v160 offset:18688
    ds_read_b32 v85, v160 offset:18944
    ds_read_b32 v86, v160 offset:19200
    s_lshr_b32 s62, s60, 1
    s_add_u32 s62, s62, 52736
    v_add_u32 v141, s62, v141
    v_lshl_add_u32 v158, v154, 1, s62
    s_mov_b32 s62, 0x03020302
    s_mov_b32 s63, 0x8001
    s_waitcnt lgkmcnt(5)
    v_and_b32 v132, 16383, v132
    v_and_b32 v134, 16383, v134
    v_and_b32 v136, 16383, v136
    v_and_b32 v138, 16383, v138
    buffer_load_dwordx4 v[132:133], s[36:39], s48 idxen offen offset:0 sc1 lds
    buffer_load_dwordx4 v[134:135], s[36:39], s49 idxen offen offset:1024 sc1 lds
    buffer_load_dwordx4 v[136:137], s[36:39], s50 idxen offen offset:2048 sc1 lds
    buffer_load_dwordx4 v[138:139], s[36:39], s51 idxen offen offset:3072 sc1 lds
    s_lshl_b32 s31, s57, 4
    s_waitcnt lgkmcnt(0)
    v_and_b32 v87, 0xc000, v82
    v_perm_b32 v64, v82, v82, s62
    v_xor_b32 v82, v82, v87
    v_mul_u32_u24 v87, s63, v87
    v_and_b32 v87, 0x40004000, v87
    v_and_b32 v88, 0xc000, v83
    v_perm_b32 v65, v83, v83, s62
    v_xor_b32 v83, v83, v88
    v_mul_u32_u24 v88, s63, v88
    v_and_b32 v88, 0x40004000, v88
    v_and_b32 v89, 0xc000, v84
    v_perm_b32 v66, v84, v84, s62
    v_xor_b32 v84, v84, v89
    v_mul_u32_u24 v89, s63, v89
    v_and_b32 v89, 0x40004000, v89
    v_and_b32 v90, 0xc000, v85
    v_perm_b32 v67, v85, v85, s62
    v_xor_b32 v85, v85, v90
    v_mul_u32_u24 v90, s63, v90
    v_and_b32 v90, 0x40004000, v90
    s_sub_u32 s34, s31, 256
    s_cbranch_scc1 K_few
    ds_write2st64_b32 v160, v87, v64 offset0:16 offset1:71
    ds_write_b16 v158, v82 offset:0
    ds_write2st64_b32 v160, v88, v65 offset0:17 offset1:72
    ds_write_b16 v158, v83 offset:128
    ds_write2st64_b32 v160, v89, v66 offset0:18 offset1:73
    ds_write_b16 v158, v84 offset:256
    ds_write2st64_b32 v160, v90, v67 offset0:19 offset1:74
    ds_write_b16 v158, v85 offset:384
    s_bfm_b64 exec, s34, 0
    s_cbranch_execz K_put
    v_and_b32 v91, 0xc000, v86
    v_perm_b32 v68, v86, v86, s62
    v_xor_b32 v86, v86, v91
    v_mul_u32_u24 v91, s63, v91
    v_and_b32 v91, 0x40004000, v91
    ds_write2st64_b32 v160, v91, v68 offset0:20 offset1:75
    ds_write_b16 v158, v86 offset:512
    s_branch K_put
K_few:
    s_mov_b64 exec, -1
    v_cmp_gt_i32 vcc, s31, v154
    s_sub_u32 s31, s31, 64
    s_mov_b64 exec, vcc
    ds_write2st64_b32 v160, v87, v64 offset0:16 offset1:71
    ds_write_b16 v158, v82 offset:0
    s_mov_b64 exec, -1
    v_cmp_gt_i32 vcc, s31, v154
    s_sub_u32 s31, s31, 64
    s_mov_b64 exec, vcc
    ds_write2st64_b32 v160, v88, v65 offset0:17 offset1:72
    ds_write_b16 v158, v83 offset:128
    s_mov_b64 exec, -1
    v_cmp_gt_i32 vcc, s31, v154
    s_sub_u32 s31, s31, 64
    s_mov_b64 exec, vcc
    ds_write2st64_b32 v160, v89, v66 offset0:18 offset1:73
    ds_write_b16 v158, v84 offset:256
    s_mov_b64 exec, -1
    v_cmp_gt_i32 vcc, s31, v154
    s_sub_u32 s31, s31, 64
    s_mov_b64 exec, vcc
    ds_write2st64_b32 v160, v90, v67 offset0:19 offset1:74
    ds_write_b16 v158, v85 offset:384
K_put:
    s_mov_b64 exec, -1
    s_lshl_b32 s62, s61, 9
    s_add_u32 s62, s62, 60416
    v_add_u32 v143, s62, v159
    v_lshrrev_b32 v162, 7, v144
    v_mad_u32_u24 v142, v162, s60, v142
    ds_read_b32 v96, v142 offset:0
    ds_read_b32 v97, v142 offset:14080
    ds_read_b32 v98, v143 offset:0
    ds_read_b32 v100, v143 offset:256
    ds_read_u16 v132, v141 offset:32
    ds_read_u16 v134, v141 offset:40
    ds_read_u16 v136, v141 offset:48
    ds_read_u16 v138, v141 offset:56
    s_add_u32 s62, s61, s59
    s_mul_i32 s62, s62, 288
    s_add_u32 s62, s62, 32256
    v_add_u32 v145, s62, v159
    v_add_u32 v143, 0x200, v143
    v_sub_u32 v158, s57, v154
    s_movk_i32 s62, 960
    s_mov_b32 s63, 0x4003050
    v_cmp_eq_u32 vcc, 0, v158
    v_min_u32 v158, 10, v158
    v_mad_u32_u24 v162, v80, s62, v114
    v_mul_u32_u24 v158, 3, v158
    v_bfe_u32 v158, s63, v158, 3
    v_mov_b32 v161, K_exit - K_vbase
    v_mad_i32_i24 v162, v158, -8, v162
    v_cndmask_b32 v162, v162, v161, vcc
    ds_bpermute_b32 v148, v159, v162 offset:4
    s_mov_b32 s31, 1
    v_readlane_b32 s34, v162, 0
    s_mov_b64 vcc, 0
    s_setprio 3
    s_waitcnt vmcnt(0)
    ds_read_b64_tr_b16 v[0:1], v140 offset:0
    ds_read_b64_tr_b16 v[16:17], v140 offset:128
    ds_read_b64_tr_b16 v[2:3], v140 offset:512
    ds_read_b64_tr_b16 v[18:19], v140 offset:640
    ds_read_b64_tr_b16 v[4:5], v140 offset:1024
    ds_read_b64_tr_b16 v[20:21], v140 offset:1152
    ds_read_b64_tr_b16 v[6:7], v140 offset:1536
    ds_read_b64_tr_b16 v[22:23], v140 offset:1664
    ds_read_b64_tr_b16 v[8:9], v140 offset:2048
    ds_read_b64_tr_b16 v[24:25], v140 offset:2176
    ds_read_b64_tr_b16 v[10:11], v140 offset:2560
    ds_read_b64_tr_b16 v[26:27], v140 offset:2688
    ds_read_b64_tr_b16 v[12:13], v140 offset:3072
    ds_read_b64_tr_b16 v[28:29], v140 offset:3200
    ds_read_b64_tr_b16 v[14:15], v140 offset:3584
    ds_read_b64_tr_b16 v[30:31], v140 offset:3712
    s_add_u32 s34, s34, s32
    s_addc_u32 s35, s33, 0
    s_waitcnt lgkmcnt(0)
    v_mfma_f32_32x32x8_bf16 v[0:15], v[96:97], v[98:99], v[0:15]
    buffer_load_dwordx4 v[132:133], s[36:39], s48 idxen offen offset:0 sc1 lds
    buffer_load_dwordx4 v[134:135], s[36:39], s49 idxen offen offset:1024 sc1 lds
    buffer_load_dwordx4 v[136:137], s[36:39], s50 idxen offen offset:2048 sc1 lds
    buffer_load_dwordx4 v[138:139], s[36:39], s51 idxen offen offset:3072 sc1 lds
    v_mfma_f32_32x32x8_bf16 v[16:31], v[96:97], v[100:101], v[16:31]
    v_lshl_or_b32 v148, v148, 16, v162
    s_nop 9
    s_setpc_b64 s[34:35]
.p2align 6
K_vbase:
.org K_vbase + 0, 0
    s_setprio 2
    s_branch K_var0N
    s_setprio 1
    s_branch K_var0N
    s_mov_b64 vcc, -1
    s_branch K_var0N
    s_setprio 0
    s_mov_b32 s38, 0
K_var0N:
    v_exp_f32 v64, v0
    v_exp_f32 v65, v1
    v_exp_f32 v80, v16
    v_exp_f32 v81, v17
    v_exp_f32 v66, v2
    v_exp_f32 v67, v3
    v_exp_f32 v82, v18
    v_exp_f32 v83, v19
    v_exp_f32 v68, v4
    v_exp_f32 v69, v5
    v_exp_f32 v84, v20
    v_exp_f32 v85, v21
    v_exp_f32 v70, v6
    v_exp_f32 v71, v7
    v_exp_f32 v86, v22
    v_exp_f32 v87, v23
    v_exp_f32 v72, v8
    v_exp_f32 v73, v9
    v_exp_f32 v88, v24
    v_exp_f32 v89, v25
    v_exp_f32 v74, v10
    v_exp_f32 v75, v11
    v_exp_f32 v90, v26
    v_exp_f32 v91, v27
.p2align 3
    v_pk_fma_f32 v[110:111], v[0:1], v[104:105], v[102:103]
    v_pk_fma_f32 v[112:113], v[16:17], v[108:109], v[106:107]
    v_pk_fma_f32 v[104:105], v[104:105], v[64:65], v[104:105]
    v_pk_fma_f32 v[108:109], v[108:109], v[80:81], v[108:109]
    v_pk_fma_f32 v[102:103], v[102:103], v[64:65], v[110:111]
    v_pk_fma_f32 v[106:107], v[106:107], v[80:81], v[112:113]
    v_pk_fma_f32 v[110:111], v[2:3], v[104:105], v[102:103]
    v_pk_fma_f32 v[112:113], v[18:19], v[108:109], v[106:107]
    v_pk_fma_f32 v[104:105], v[104:105], v[66:67], v[104:105]
    v_pk_fma_f32 v[108:109], v[108:109], v[82:83], v[108:109]
    v_pk_fma_f32 v[102:103], v[102:103], v[66:67], v[110:111]
    v_pk_fma_f32 v[106:107], v[106:107], v[82:83], v[112:113]
    v_pk_fma_f32 v[110:111], v[4:5], v[104:105], v[102:103]
    v_pk_fma_f32 v[112:113], v[20:21], v[108:109], v[106:107]
    v_pk_fma_f32 v[104:105], v[104:105], v[68:69], v[104:105]
    v_pk_fma_f32 v[108:109], v[108:109], v[84:85], v[108:109]
    v_pk_fma_f32 v[102:103], v[102:103], v[68:69], v[110:111]
    v_pk_fma_f32 v[106:107], v[106:107], v[84:85], v[112:113]
    v_pk_fma_f32 v[110:111], v[6:7], v[104:105], v[102:103]
    v_pk_fma_f32 v[112:113], v[22:23], v[108:109], v[106:107]
    v_pk_fma_f32 v[104:105], v[104:105], v[70:71], v[104:105]
    v_pk_fma_f32 v[108:109], v[108:109], v[86:87], v[108:109]
    v_pk_fma_f32 v[102:103], v[102:103], v[70:71], v[110:111]
    v_pk_fma_f32 v[106:107], v[106:107], v[86:87], v[112:113]
    s_cbranch_vccnz K_va0N
    s_waitcnt vmcnt(0)
    ds_read_b32 v96, v142 offset:64
    ds_read_b32 v97, v142 offset:14144
    ds_read_b64_tr_b16 v[32:33], v140 offset:0
    ds_read_b64_tr_b16 v[48:49], v140 offset:128
    ds_read_b64_tr_b16 v[34:35], v140 offset:512
    ds_read_b64_tr_b16 v[50:51], v140 offset:640
    ds_read_b64_tr_b16 v[36:37], v140 offset:1024
    ds_read_b64_tr_b16 v[52:53], v140 offset:1152
    ds_read_b64_tr_b16 v[38:39], v140 offset:1536
    ds_read_b64_tr_b16 v[54:55], v140 offset:1664
    ds_read_b64_tr_b16 v[40:41], v140 offset:2048
    ds_read_b64_tr_b16 v[56:57], v140 offset:2176
    ds_read_b64_tr_b16 v[42:43], v140 offset:2560
    ds_read_b64_tr_b16 v[58:59], v140 offset:2688
    ds_read_b64_tr_b16 v[44:45], v140 offset:3072
    ds_read_b64_tr_b16 v[60:61], v140 offset:3200
    ds_read_b64_tr_b16 v[46:47], v140 offset:3584
    ds_read_b64_tr_b16 v[62:63], v140 offset:3712
    ds_read_u16 v132, v141 offset:64
    ds_read_u16 v134, v141 offset:72
    ds_read_u16 v136, v141 offset:80
    ds_read_u16 v138, v141 offset:88
.p2align 3
K_va0N:
.p2align 3
    v_pk_fma_f32 v[110:111], v[8:9], v[104:105], v[102:103]
    v_pk_fma_f32 v[112:113], v[24:25], v[108:109], v[106:107]
    v_pk_fma_f32 v[104:105], v[104:105], v[72:73], v[104:105]
    v_pk_fma_f32 v[108:109], v[108:109], v[88:89], v[108:109]
    v_pk_fma_f32 v[102:103], v[102:103], v[72:73], v[110:111]
    v_pk_fma_f32 v[106:107], v[106:107], v[88:89], v[112:113]
    v_pk_fma_f32 v[110:111], v[10:11], v[104:105], v[102:103]
    v_pk_fma_f32 v[112:113], v[26:27], v[108:109], v[106:107]
    v_pk_fma_f32 v[104:105], v[104:105], v[74:75], v[104:105]
    v_pk_fma_f32 v[108:109], v[108:109], v[90:91], v[108:109]
    v_pk_fma_f32 v[102:103], v[102:103], v[74:75], v[110:111]
    v_pk_fma_f32 v[106:107], v[106:107], v[90:91], v[112:113]
    s_cbranch_vccnz K_vb0N
    s_waitcnt lgkmcnt(0)
    buffer_load_dwordx4 v[132:133], s[36:39], s48 idxen offen offset:0 sc1 lds
    buffer_load_dwordx4 v[134:135], s[36:39], s49 idxen offen offset:1024 sc1 lds
    buffer_load_dwordx4 v[136:137], s[36:39], s50 idxen offen offset:2048 sc1 lds
    buffer_load_dwordx4 v[138:139], s[36:39], s51 idxen offen offset:3072 sc1 lds
    v_mfma_f32_32x32x8_bf16 v[32:47], v[96:97], v[98:99], v[32:47]
K_vb0N:
    v_exp_f32 v76, v12
    v_exp_f32 v77, v13
    v_exp_f32 v92, v28
    v_exp_f32 v93, v29
    v_mfma_f32_32x32x8_bf16 v[48:63], v[96:97], v[100:101], v[48:63]
    v_exp_f32 v78, v14
    v_exp_f32 v79, v15
    v_exp_f32 v94, v30
    v_exp_f32 v95, v31
    v_readlane_b32 s52, v148, s31
    s_and_b32 s34, s52, 0xffff
    s_add_u32 s31, s31, 2
    s_add_u32 s34, s34, s32
    s_addc_u32 s35, s33, 0
.p2align 3
    v_pk_fma_f32 v[110:111], v[12:13], v[104:105], v[102:103]
    v_pk_fma_f32 v[112:113], v[28:29], v[108:109], v[106:107]
    v_pk_fma_f32 v[104:105], v[104:105], v[76:77], v[104:105]
    v_pk_fma_f32 v[108:109], v[108:109], v[92:93], v[108:109]
    v_pk_fma_f32 v[102:103], v[102:103], v[76:77], v[110:111]
    v_pk_fma_f32 v[106:107], v[106:107], v[92:93], v[112:113]
    v_pk_fma_f32 v[110:111], v[14:15], v[104:105], v[102:103]
    v_pk_fma_f32 v[112:113], v[30:31], v[108:109], v[106:107]
    v_pk_fma_f32 v[104:105], v[104:105], v[78:79], v[104:105]
    v_pk_fma_f32 v[108:109], v[108:109], v[94:95], v[108:109]
    v_pk_fma_f32 v[102:103], v[102:103], v[78:79], v[110:111]
    v_pk_fma_f32 v[106:107], v[106:107], v[94:95], v[112:113]
    s_setpc_b64 s[34:35]
.org K_vbase + 960, 0
    s_setprio 2
    s_branch K_var00
    s_setprio 1
    s_branch K_var00
    s_mov_b64 vcc, -1
    s_branch K_var00
    s_setprio 0
    s_mov_b32 s38, 0
K_var00:
    v_exp_f32 v64, v0
    v_exp_f32 v65, v1
    v_exp_f32 v80, v16
    v_exp_f32 v81, v17
    v_exp_f32 v66, v2
    v_exp_f32 v67, v3
    v_exp_f32 v82, v18
    v_exp_f32 v83, v19
    v_exp_f32 v68, v4
    v_exp_f32 v69, v5
    v_exp_f32 v84, v20
    v_exp_f32 v85, v21
    v_exp_f32 v70, v6
    v_exp_f32 v71, v7
    v_exp_f32 v86, v22
    v_exp_f32 v87, v23
    v_exp_f32 v72, v8
    v_exp_f32 v73, v9
    v_exp_f32 v88, v24
    v_exp_f32 v89, v25
    v_exp_f32 v74, v10
    v_exp_f32 v75, v11
    v_exp_f32 v90, v26
    v_exp_f32 v91, v27
.p2align 3
    v_rcp_f32 v114, v104
    v_rcp_f32 v115, v105
    v_rcp_f32 v116, v108
    v_rcp_f32 v117, v109
    v_pk_add_f32 v[104:105], v[64:65], 1.0 op_sel_hi:[1,0]
    v_pk_add_f32 v[108:109], v[80:81], 1.0 op_sel_hi:[1,0]
    v_pk_mul_f32 v[118:119], v[102:103], v[114:115]
    v_pk_mul_f32 v[120:121], v[106:107], v[116:117]
    v_min3_f32 v146, v146, v114, v115
    v_min3_f32 v146, v146, v116, v117
    v_add_f32 v118, v118, v119
    v_add_f32 v120, v120, v121
    v_cvt_pk_bf16_f32 v118, v118, v120
    ds_write_b32 v145, v118
    v_pk_fma_f32 v[110:111], v[2:3], v[104:105], v[0:1]
    v_pk_fma_f32 v[112:113], v[18:19], v[108:109], v[16:17]
    v_pk_fma_f32 v[104:105], v[104:105], v[66:67], v[104:105]
    v_pk_fma_f32 v[108:109], v[108:109], v[82:83], v[108:109]
    v_pk_fma_f32 v[102:103], v[0:1], v[66:67], v[110:111]
    v_pk_fma_f32 v[106:107], v[16:17], v[82:83], v[112:113]
    v_pk_fma_f32 v[110:111], v[4:5], v[104:105], v[102:103]
    v_pk_fma_f32 v[112:113], v[20:21], v[108:109], v[106:107]
    v_pk_fma_f32 v[104:105], v[104:105], v[68:69], v[104:105]
    v_pk_fma_f32 v[108:109], v[108:109], v[84:85], v[108:109]
    v_pk_fma_f32 v[102:103], v[102:103], v[68:69], v[110:111]
    v_pk_fma_f32 v[106:107], v[106:107], v[84:85], v[112:113]
    v_pk_fma_f32 v[110:111], v[6:7], v[104:105], v[102:103]
    v_pk_fma_f32 v[112:113], v[22:23], v[108:109], v[106:107]
    v_pk_fma_f32 v[104:105], v[104:105], v[70:71], v[104:105]
    v_pk_fma_f32 v[108:109], v[108:109], v[86:87], v[108:109]
    v_pk_fma_f32 v[102:103], v[102:103], v[70:71], v[110:111]
    v_pk_fma_f32 v[106:107], v[106:107], v[86:87], v[112:113]
    s_cbranch_vccnz K_va00
    s_waitcnt vmcnt(0)
    ds_read_b32 v96, v142 offset:64
    ds_read_b32 v97, v142 offset:14144
    ds_read_b32 v98, v143 offset:0
    ds_read_b32 v100, v143 offset:256
    ds_read_b64_tr_b16 v[32:33], v140 offset:0
    ds_read_b64_tr_b16 v[48:49], v140 offset:128
    ds_read_b64_tr_b16 v[34:35], v140 offset:512
    ds_read_b64_tr_b16 v[50:51], v140 offset:640
    ds_read_b64_tr_b16 v[36:37], v140 offset:1024
    ds_read_b64_tr_b16 v[52:53], v140 offset:1152
    ds_read_b64_tr_b16 v[38:39], v140 offset:1536
    ds_read_b64_tr_b16 v[54:55], v140 offset:1664
    ds_read_b64_tr_b16 v[40:41], v140 offset:2048
    ds_read_b64_tr_b16 v[56:57], v140 offset:2176
    ds_read_b64_tr_b16 v[42:43], v140 offset:2560
    ds_read_b64_tr_b16 v[58:59], v140 offset:2688
    ds_read_b64_tr_b16 v[44:45], v140 offset:3072
    ds_read_b64_tr_b16 v[60:61], v140 offset:3200
    ds_read_b64_tr_b16 v[46:47], v140 offset:3584
    ds_read_b64_tr_b16 v[62:63], v140 offset:3712
    ds_read_u16 v132, v141 offset:64
    ds_read_u16 v134, v141 offset:72
    ds_read_u16 v136, v141 offset:80
    ds_read_u16 v138, v141 offset:88
.p2align 3
K_va00:
.p2align 3
    v_pk_fma_f32 v[110:111], v[8:9], v[104:105], v[102:103]
    v_pk_fma_f32 v[112:113], v[24:25], v[108:109], v[106:107]
    v_pk_fma_f32 v[104:105], v[104:105], v[72:73], v[104:105]
    v_pk_fma_f32 v[108:109], v[108:109], v[88:89], v[108:109]
    v_pk_fma_f32 v[102:103], v[102:103], v[72:73], v[110:111]
    v_pk_fma_f32 v[106:107], v[106:107], v[88:89], v[112:113]
    v_pk_fma_f32 v[110:111], v[10:11], v[104:105], v[102:103]
    v_pk_fma_f32 v[112:113], v[26:27], v[108:109], v[106:107]
    v_pk_fma_f32 v[104:105], v[104:105], v[74:75], v[104:105]
    v_pk_fma_f32 v[108:109], v[108:109], v[90:91], v[108:109]
    v_pk_fma_f32 v[102:103], v[102:103], v[74:75], v[110:111]
    v_pk_fma_f32 v[106:107], v[106:107], v[90:91], v[112:113]
    s_cbranch_vccnz K_vb00
    s_waitcnt lgkmcnt(0)
    buffer_load_dwordx4 v[132:133], s[36:39], s48 idxen offen offset:0 sc1 lds
    buffer_load_dwordx4 v[134:135], s[36:39], s49 idxen offen offset:1024 sc1 lds
    buffer_load_dwordx4 v[136:137], s[36:39], s50 idxen offen offset:2048 sc1 lds
    buffer_load_dwordx4 v[138:139], s[36:39], s51 idxen offen offset:3072 sc1 lds
    v_mfma_f32_32x32x8_bf16 v[32:47], v[96:97], v[98:99], v[32:47]
K_vb00:
    v_exp_f32 v76, v12
    v_exp_f32 v77, v13
    v_exp_f32 v92, v28
    v_exp_f32 v93, v29
    v_mfma_f32_32x32x8_bf16 v[48:63], v[96:97], v[100:101], v[48:63]
    v_exp_f32 v78, v14
    v_exp_f32 v79, v15
    v_exp_f32 v94, v30
    v_exp_f32 v95, v31
    v_readlane_b32 s52, v148, s31
    v_add_u32 v143, 0x200, v143
    s_and_b32 s34, s52, 0xffff
    s_add_u32 s31, s31, 2
    s_add_u32 s34, s34, s32
    s_addc_u32 s35, s33, 0
.p2align 3
    v_pk_fma_f32 v[110:111], v[12:13], v[104:105], v[102:103]
    v_pk_fma_f32 v[112:113], v[28:29], v[108:109], v[106:107]
    v_pk_fma_f32 v[104:105], v[104:105], v[76:77], v[104:105]
    v_pk_fma_f32 v[108:109], v[108:109], v[92:93], v[108:109]
    v_pk_fma_f32 v[102:103], v[102:103], v[76:77], v[110:111]
    v_pk_fma_f32 v[106:107], v[106:107], v[92:93], v[112:113]
    v_pk_fma_f32 v[110:111], v[14:15], v[104:105], v[102:103]
    v_pk_fma_f32 v[112:113], v[30:31], v[108:109], v[106:107]
    v_pk_fma_f32 v[104:105], v[104:105], v[78:79], v[104:105]
    v_pk_fma_f32 v[108:109], v[108:109], v[94:95], v[108:109]
    v_pk_fma_f32 v[102:103], v[102:103], v[78:79], v[110:111]
    v_pk_fma_f32 v[106:107], v[106:107], v[94:95], v[112:113]
    v_add_u32 v145, 288, v145
    s_setpc_b64 s[34:35]
.org K_vbase + 1920, 0
    s_setprio 2
    s_branch K_var01
    s_setprio 1
    s_branch K_var01
    s_mov_b64 vcc, -1
    s_branch K_var01
    s_setprio 0
    s_mov_b32 s38, 0
K_var01:
    v_exp_f32 v64, v0
    v_exp_f32 v65, v1
    v_exp_f32 v80, v16
    v_exp_f32 v81, v17
    v_exp_f32 v66, v2
    v_exp_f32 v67, v3
    v_exp_f32 v82, v18
    v_exp_f32 v83, v19
    v_exp_f32 v68, v4
    v_exp_f32 v69, v5
    v_exp_f32 v84, v20
    v_exp_f32 v85, v21
    v_exp_f32 v70, v6
    v_exp_f32 v71, v7
    v_exp_f32 v86, v22
    v_exp_f32 v87, v23
    v_exp_f32 v72, v8
    v_exp_f32 v73, v9
    v_exp_f32 v88, v24
    v_exp_f32 v89, v25
    v_exp_f32 v74, v10
    v_exp_f32 v75, v11
    v_exp_f32 v90, v26
    v_exp_f32 v91, v27
.p2align 3
    v_pk_fma_f32 v[110:111], v[0:1], v[104:105], v[102:103]
    v_pk_fma_f32 v[112:113], v[16:17], v[108:109], v[106:107]
    v_pk_fma_f32 v[104:105], v[104:105], v[64:65], v[104:105]
    v_pk_fma_f32 v[108:109], v[108:109], v[80:81], v[108:109]
    v_pk_fma_f32 v[102:103], v[102:103], v[64:65], v[110:111]
    v_pk_fma_f32 v[106:107], v[106:107], v[80:81], v[112:113]
    v_rcp_f32 v114, v104
    v_rcp_f32 v115, v105
    v_rcp_f32 v116, v108
    v_rcp_f32 v117, v109
    v_pk_add_f32 v[104:105], v[66:67], 1.0 op_sel_hi:[1,0]
    v_pk_add_f32 v[108:109], v[82:83], 1.0 op_sel_hi:[1,0]
    v_pk_mul_f32 v[118:119], v[102:103], v[114:115]
    v_pk_mul_f32 v[120:121], v[106:107], v[116:117]
    v_min3_f32 v146, v146, v114, v115
    v_min3_f32 v146, v146, v116, v117
    v_add_f32 v118, v118, v119
    v_add_f32 v120, v120, v121
    v_cvt_pk_bf16_f32 v118, v118, v120
    ds_write_b32 v145, v118
    v_pk_fma_f32 v[110:111], v[4:5], v[104:105], v[2:3]
    v_pk_fma_f32 v[112:113], v[20:21], v[108:109], v[18:19]
    v_pk_fma_f32 v[104:105], v[104:105], v[68:69], v[104:105]
    v_pk_fma_f32 v[108:109], v[108:109], v[84:85], v[108:109]
    v_pk_fma_f32 v[102:103], v[2:3], v[68:69], v[110:111]
    v_pk_fma_f32 v[106:107], v[18:19], v[84:85], v[112:113]
    v_pk_fma_f32 v[110:111], v[6:7], v[104:105], v[102:103]
    v_pk_fma_f32 v[112:113], v[22:23], v[108:109], v[106:107]
    v_pk_fma_f32 v[104:105], v[104:105], v[70:71], v[104:105]
    v_pk_fma_f32 v[108:109], v[108:109], v[86:87], v[108:109]
    v_pk_fma_f32 v[102:103], v[102:103], v[70:71], v[110:111]
    v_pk_fma_f32 v[106:107], v[106:107], v[86:87], v[112:113]
    s_cbranch_vccnz K_va01
    s_waitcnt vmcnt(0)
    ds_read_b32 v96, v142 offset:64
    ds_read_b32 v97, v142 offset:14144
    ds_read_b32 v98, v143 offset:0
    ds_read_b32 v100, v143 offset:256
    ds_read_b64_tr_b16 v[32:33], v140 offset:0
    ds_read_b64_tr_b16 v[48:49], v140 offset:128
    ds_read_b64_tr_b16 v[34:35], v140 offset:512
    ds_read_b64_tr_b16 v[50:51], v140 offset:640
    ds_read_b64_tr_b16 v[36:37], v140 offset:1024
    ds_read_b64_tr_b16 v[52:53], v140 offset:1152
    ds_read_b64_tr_b16 v[38:39], v140 offset:1536
    ds_read_b64_tr_b16 v[54:55], v140 offset:1664
    ds_read_b64_tr_b16 v[40:41], v140 offset:2048
    ds_read_b64_tr_b16 v[56:57], v140 offset:2176
    ds_read_b64_tr_b16 v[42:43], v140 offset:2560
    ds_read_b64_tr_b16 v[58:59], v140 offset:2688
    ds_read_b64_tr_b16 v[44:45], v140 offset:3072
    ds_read_b64_tr_b16 v[60:61], v140 offset:3200
    ds_read_b64_tr_b16 v[46:47], v140 offset:3584
    ds_read_b64_tr_b16 v[62:63], v140 offset:3712
    ds_read_u16 v132, v141 offset:64
    ds_read_u16 v134, v141 offset:72
    ds_read_u16 v136, v141 offset:80
    ds_read_u16 v138, v141 offset:88
.p2align 3
K_va01:
.p2align 3
    v_pk_fma_f32 v[110:111], v[8:9], v[104:105], v[102:103]
    v_pk_fma_f32 v[112:113], v[24:25], v[108:109], v[106:107]
    v_pk_fma_f32 v[104:105], v[104:105], v[72:73], v[104:105]
    v_pk_fma_f32 v[108:109], v[108:109], v[88:89], v[108:109]
    v_pk_fma_f32 v[102:103], v[102:103], v[72:73], v[110:111]
    v_pk_fma_f32 v[106:107], v[106:107], v[88:89], v[112:113]
    v_pk_fma_f32 v[110:111], v[10:11], v[104:105], v[102:103]
    v_pk_fma_f32 v[112:113], v[26:27], v[108:109], v[106:107]
    v_pk_fma_f32 v[104:105], v[104:105], v[74:75], v[104:105]
    v_pk_fma_f32 v[108:109], v[108:109], v[90:91], v[108:109]
    v_pk_fma_f32 v[102:103], v[102:103], v[74:75], v[110:111]
    v_pk_fma_f32 v[106:107], v[106:107], v[90:91], v[112:113]
    s_cbranch_vccnz K_vb01
    s_waitcnt lgkmcnt(0)
    buffer_load_dwordx4 v[132:133], s[36:39], s48 idxen offen offset:0 sc1 lds
    buffer_load_dwordx4 v[134:135], s[36:39], s49 idxen offen offset:1024 sc1 lds
    buffer_load_dwordx4 v[136:137], s[36:39], s50 idxen offen offset:2048 sc1 lds
    buffer_load_dwordx4 v[138:139], s[36:39], s51 idxen offen offset:3072 sc1 lds
    v_mfma_f32_32x32x8_bf16 v[32:47], v[96:97], v[98:99], v[32:47]
K_vb01:
    v_exp_f32 v76, v12
    v_exp_f32 v77, v13
    v_exp_f32 v92, v28
    v_exp_f32 v93, v29
    v_mfma_f32_32x32x8_bf16 v[48:63], v[96:97], v[100:101], v[48:63]
    v_exp_f32 v78, v14
    v_exp_f32 v79, v15
    v_exp_f32 v94, v30
    v_exp_f32 v95, v31
    v_readlane_b32 s52, v148, s31
    v_add_u32 v143, 0x200, v143
    s_and_b32 s34, s52, 0xffff
    s_add_u32 s31, s31, 2
    s_add_u32 s34, s34, s32
    s_addc_u32 s35, s33, 0
.p2align 3
    v_pk_fma_f32 v[110:111], v[12:13], v[104:105], v[102:103]
    v_pk_fma_f32 v[112:113], v[28:29], v[108:109], v[106:107]
    v_pk_fma_f32 v[104:105], v[104:105], v[76:77], v[104:105]
    v_pk_fma_f32 v[108:109], v[108:109], v[92:93], v[108:109]
    v_pk_fma_f32 v[102:103], v[102:103], v[76:77], v[110:111]
    v_pk_fma_f32 v[106:107], v[106:107], v[92:93], v[112:113]
    v_pk_fma_f32 v[110:111], v[14:15], v[104:105], v[102:103]
    v_pk_fma_f32 v[112:113], v[30:31], v[108:109], v[106:107]
    v_pk_fma_f32 v[104:105], v[104:105], v[78:79], v[104:105]
    v_pk_fma_f32 v[108:109], v[108:109], v[94:95], v[108:109]
    v_pk_fma_f32 v[102:103], v[102:103], v[78:79], v[110:111]
    v_pk_fma_f32 v[106:107], v[106:107], v[94:95], v[112:113]
    v_add_u32 v145, 288, v145
    s_setpc_b64 s[34:35]
.org K_vbase + 2880, 0
    s_setprio 2
    s_branch K_var02
    s_setprio 1
    s_branch K_var02
    s_mov_b64 vcc, -1
    s_branch K_var02
    s_setprio 0
    s_mov_b32 s38, 0
K_var02:
    v_exp_f32 v64, v0
    v_exp_f32 v65, v1
    v_exp_f32 v80, v16
    v_exp_f32 v81, v17
    v_exp_f32 v66, v2
    v_exp_f32 v67, v3
    v_exp_f32 v82, v18
    v_exp_f32 v83, v19
    v_exp_f32 v68, v4
    v_exp_f32 v69, v5
    v_exp_f32 v84, v20
    v_exp_f32 v85, v21
    v_exp_f32 v70, v6
    v_exp_f32 v71, v7
    v_exp_f32 v86, v22
    v_exp_f32 v87, v23
    v_exp_f32 v72, v8
    v_exp_f32 v73, v9
    v_exp_f32 v88, v24
    v_exp_f32 v89, v25
    v_exp_f32 v74, v10
    v_exp_f32 v75, v11
    v_exp_f32 v90, v26
    v_exp_f32 v91, v27
.p2align 3
    v_pk_fma_f32 v[110:111], v[0:1], v[104:105], v[102:103]
    v_pk_fma_f32 v[112:113], v[16:17], v[108:109], v[106:107]
    v_pk_fma_f32 v[104:105], v[104:105], v[64:65], v[104:105]
    v_pk_fma_f32 v[108:109], v[108:109], v[80:81], v[108:109]
    v_pk_fma_f32 v[102:103], v[102:103], v[64:65], v[110:111]
    v_pk_fma_f32 v[106:107], v[106:107], v[80:81], v[112:113]
    v_pk_fma_f32 v[110:111], v[2:3], v[104:105], v[102:103]
    v_pk_fma_f32 v[112:113], v[18:19], v[108:109], v[106:107]
    v_pk_fma_f32 v[104:105], v[104:105], v[66:67], v[104:105]
    v_pk_fma_f32 v[108:109], v[108:109], v[82:83], v[108:109]
    v_pk_fma_f32 v[102:103], v[102:103], v[66:67], v[110:111]
    v_pk_fma_f32 v[106:107], v[106:107], v[82:83], v[112:113]
    v_rcp_f32 v114, v104
    v_rcp_f32 v115, v105
    v_rcp_f32 v116, v108
    v_rcp_f32 v117, v109
    v_pk_add_f32 v[104:105], v[68:69], 1.0 op_sel_hi:[1,0]
    v_pk_add_f32 v[108:109], v[84:85], 1.0 op_sel_hi:[1,0]
    v_pk_mul_f32 v[118:119], v[102:103], v[114:115]
    v_pk_mul_f32 v[120:121], v[106:107], v[116:117]
    v_min3_f32 v146, v146, v114, v115
    v_min3_f32 v146, v146, v116, v117
    v_add_f32 v118, v118, v119
    v_add_f32 v120, v120, v121
    v_cvt_pk_bf16_f32 v118, v118, v120
    ds_write_b32 v145, v118
    v_pk_fma_f32 v[110:111], v[6:7], v[104:105], v[4:5]
    v_pk_fma_f32 v[112:113], v[22:23], v[108:109], v[20:21]
    v_pk_fma_f32 v[104:105], v[104:105], v[70:71], v[104:105]
    v_pk_fma_f32 v[108:109], v[108:109], v[86:87], v[108:109]
    v_pk_fma_f32 v[102:103], v[4:5], v[70:71], v[110:111]
    v_pk_fma_f32 v[106:107], v[20:21], v[86:87], v[112:113]
    s_cbranch_vccnz K_va02
    s_waitcnt vmcnt(0)
    ds_read_b32 v96, v142 offset:64
    ds_read_b32 v97, v142 offset:14144
    ds_read_b32 v98, v143 offset:0
    ds_read_b32 v100, v143 offset:256
    ds_read_b64_tr_b16 v[32:33], v140 offset:0
    ds_read_b64_tr_b16 v[48:49], v140 offset:128
    ds_read_b64_tr_b16 v[34:35], v140 offset:512
    ds_read_b64_tr_b16 v[50:51], v140 offset:640
    ds_read_b64_tr_b16 v[36:37], v140 offset:1024
    ds_read_b64_tr_b16 v[52:53], v140 offset:1152
    ds_read_b64_tr_b16 v[38:39], v140 offset:1536
    ds_read_b64_tr_b16 v[54:55], v140 offset:1664
    ds_read_b64_tr_b16 v[40:41], v140 offset:2048
    ds_read_b64_tr_b16 v[56:57], v140 offset:2176
    ds_read_b64_tr_b16 v[42:43], v140 offset:2560
    ds_read_b64_tr_b16 v[58:59], v140 offset:2688
    ds_read_b64_tr_b16 v[44:45], v140 offset:3072
    ds_read_b64_tr_b16 v[60:61], v140 offset:3200
    ds_read_b64_tr_b16 v[46:47], v140 offset:3584
    ds_read_b64_tr_b16 v[62:63], v140 offset:3712
    ds_read_u16 v132, v141 offset:64
    ds_read_u16 v134, v141 offset:72
    ds_read_u16 v136, v141 offset:80
    ds_read_u16 v138, v141 offset:88
.p2align 3
K_va02:
.p2align 3
    v_pk_fma_f32 v[110:111], v[8:9], v[104:105], v[102:103]
    v_pk_fma_f32 v[112:113], v[24:25], v[108:109], v[106:107]
    v_pk_fma_f32 v[104:105], v[104:105], v[72:73], v[104:105]
    v_pk_fma_f32 v[108:109], v[108:109], v[88:89], v[108:109]
    v_pk_fma_f32 v[102:103], v[102:103], v[72:73], v[110:111]
    v_pk_fma_f32 v[106:107], v[106:107], v[88:89], v[112:113]
    v_pk_fma_f32 v[110:111], v[10:11], v[104:105], v[102:103]
    v_pk_fma_f32 v[112:113], v[26:27], v[108:109], v[106:107]
    v_pk_fma_f32 v[104:105], v[104:105], v[74:75], v[104:105]
    v_pk_fma_f32 v[108:109], v[108:109], v[90:91], v[108:109]
    v_pk_fma_f32 v[102:103], v[102:103], v[74:75], v[110:111]
    v_pk_fma_f32 v[106:107], v[106:107], v[90:91], v[112:113]
    s_cbranch_vccnz K_vb02
    s_waitcnt lgkmcnt(0)
    buffer_load_dwordx4 v[132:133], s[36:39], s48 idxen offen offset:0 sc1 lds
    buffer_load_dwordx4 v[134:135], s[36:39], s49 idxen offen offset:1024 sc1 lds
    buffer_load_dwordx4 v[136:137], s[36:39], s50 idxen offen offset:2048 sc1 lds
    buffer_load_dwordx4 v[138:139], s[36:39], s51 idxen offen offset:3072 sc1 lds
    v_mfma_f32_32x32x8_bf16 v[32:47], v[96:97], v[98:99], v[32:47]
K_vb02:
    v_exp_f32 v76, v12
    v_exp_f32 v77, v13
    v_exp_f32 v92, v28
    v_exp_f32 v93, v29
    v_mfma_f32_32x32x8_bf16 v[48:63], v[96:97], v[100:101], v[48:63]
    v_exp_f32 v78, v14
    v_exp_f32 v79, v15
    v_exp_f32 v94, v30
    v_exp_f32 v95, v31
    v_readlane_b32 s52, v148, s31
    v_add_u32 v143, 0x200, v143
    s_and_b32 s34, s52, 0xffff
    s_add_u32 s31, s31, 2
    s_add_u32 s34, s34, s32
    s_addc_u32 s35, s33, 0
.p2align 3
    v_pk_fma_f32 v[110:111], v[12:13], v[104:105], v[102:103]
    v_pk_fma_f32 v[112:113], v[28:29], v[108:109], v[106:107]
    v_pk_fma_f32 v[104:105], v[104:105], v[76:77], v[104:105]
    v_pk_fma_f32 v[108:109], v[108:109], v[92:93], v[108:109]
    v_pk_fma_f32 v[102:103], v[102:103], v[76:77], v[110:111]
    v_pk_fma_f32 v[106:107], v[106:107], v[92:93], v[112:113]
    v_pk_fma_f32 v[110:111], v[14:15], v[104:105], v[102:103]
    v_pk_fma_f32 v[112:113], v[30:31], v[108:109], v[106:107]
    v_pk_fma_f32 v[104:105], v[104:105], v[78:79], v[104:105]
    v_pk_fma_f32 v[108:109], v[108:109], v[94:95], v[108:109]
    v_pk_fma_f32 v[102:103], v[102:103], v[78:79], v[110:111]
    v_pk_fma_f32 v[106:107], v[106:107], v[94:95], v[112:113]
    v_add_u32 v145, 288, v145
    s_setpc_b64 s[34:35]
.org K_vbase + 3840, 0
    s_setprio 2
    s_branch K_var03
    s_setprio 1
    s_branch K_var03
    s_mov_b64 vcc, -1
    s_branch K_var03
    s_setprio 0
    s_mov_b32 s38, 0
K_var03:
    v_exp_f32 v64, v0
    v_exp_f32 v65, v1
    v_exp_f32 v80, v16
    v_exp_f32 v81, v17
    v_exp_f32 v66, v2
    v_exp_f32 v67, v3
    v_exp_f32 v82, v18
    v_exp_f32 v83, v19
    v_exp_f32 v68, v4
    v_exp_f32 v69, v5
    v_exp_f32 v84, v20
    v_exp_f32 v85, v21
    v_exp_f32 v70, v6
    v_exp_f32 v71, v7
    v_exp_f32 v86, v22
    v_exp_f32 v87, v23
    v_exp_f32 v72, v8
    v_exp_f32 v73, v9
    v_exp_f32 v88, v24
    v_exp_f32 v89, v25
    v_exp_f32 v74, v10
    v_exp_f32 v75, v11
    v_exp_f32 v90, v26
    v_exp_f32 v91, v27
.p2align 3
    v_pk_fma_f32 v[110:111], v[0:1], v[104:105], v[102:103]
    v_pk_fma_f32 v[112:113], v[16:17], v[108:109], v[106:107]
    v_pk_fma_f32 v[104:105], v[104:105], v[64:65], v[104:105]
    v_pk_fma_f32 v[108:109], v[108:109], v[80:81], v[108:109]
    v_pk_fma_f32 v[102:103], v[102:103], v[64:65], v[110:111]
    v_pk_fma_f32 v[106:107], v[106:107], v[80:81], v[112:113]
    v_pk_fma_f32 v[110:111], v[2:3], v[104:105], v[102:103]
    v_pk_fma_f32 v[112:113], v[18:19], v[108:109], v[106:107]
    v_pk_fma_f32 v[104:105], v[104:105], v[66:67], v[104:105]
    v_pk_fma_f32 v[108:109], v[108:109], v[82:83], v[108:109]
    v_pk_fma_f32 v[102:103], v[102:103], v[66:67], v[110:111]
    v_pk_fma_f32 v[106:107], v[106:107], v[82:83], v[112:113]
    v_pk_fma_f32 v[110:111], v[4:5], v[104:105], v[102:103]
    v_pk_fma_f32 v[112:113], v[20:21], v[108:109], v[106:107]
    v_pk_fma_f32 v[104:105], v[104:105], v[68:69], v[104:105]
    v_pk_fma_f32 v[108:109], v[108:109], v[84:85], v[108:109]
    v_pk_fma_f32 v[102:103], v[102:103], v[68:69], v[110:111]
    v_pk_fma_f32 v[106:107], v[106:107], v[84:85], v[112:113]
    v_rcp_f32 v114, v104
    v_rcp_f32 v115, v105
    v_rcp_f32 v116, v108
    v_rcp_f32 v117, v109
    v_pk_add_f32 v[104:105], v[70:71], 1.0 op_sel_hi:[1,0]
    v_pk_add_f32 v[108:109], v[86:87], 1.0 op_sel_hi:[1,0]
    v_pk_mul_f32 v[118:119], v[102:103], v[114:115]
    v_pk_mul_f32 v[120:121], v[106:107], v[116:117]
    v_min3_f32 v146, v146, v114, v115
    v_min3_f32 v146, v146, v116, v117
    v_add_f32 v118, v118, v119
    v_add_f32 v120, v120, v121
    v_cvt_pk_bf16_f32 v118, v118, v120
    ds_write_b32 v145, v118
    s_cbranch_vccnz K_va03
    s_waitcnt vmcnt(0)
    ds_read_b32 v96, v142 offset:64
    ds_read_b32 v97, v142 offset:14144
    ds_read_b32 v98, v143 offset:0
    ds_read_b32 v100, v143 offset:256
    ds_read_b64_tr_b16 v[32:33], v140 offset:0
    ds_read_b64_tr_b16 v[48:49], v140 offset:128
    ds_read_b64_tr_b16 v[34:35], v140 offset:512
    ds_read_b64_tr_b16 v[50:51], v140 offset:640
    ds_read_b64_tr_b16 v[36:37], v140 offset:1024
    ds_read_b64_tr_b16 v[52:53], v140 offset:1152
    ds_read_b64_tr_b16 v[38:39], v140 offset:1536
    ds_read_b64_tr_b16 v[54:55], v140 offset:1664
    ds_read_b64_tr_b16 v[40:41], v140 offset:2048
    ds_read_b64_tr_b16 v[56:57], v140 offset:2176
    ds_read_b64_tr_b16 v[42:43], v140 offset:2560
    ds_read_b64_tr_b16 v[58:59], v140 offset:2688
    ds_read_b64_tr_b16 v[44:45], v140 offset:3072
    ds_read_b64_tr_b16 v[60:61], v140 offset:3200
    ds_read_b64_tr_b16 v[46:47], v140 offset:3584
    ds_read_b64_tr_b16 v[62:63], v140 offset:3712
    ds_read_u16 v132, v141 offset:64
    ds_read_u16 v134, v141 offset:72
    ds_read_u16 v136, v141 offset:80
    ds_read_u16 v138, v141 offset:88
.p2align 3
K_va03:
.p2align 3
    v_pk_fma_f32 v[110:111], v[8:9], v[104:105], v[6:7]
    v_pk_fma_f32 v[112:113], v[24:25], v[108:109], v[22:23]
    v_pk_fma_f32 v[104:105], v[104:105], v[72:73], v[104:105]
    v_pk_fma_f32 v[108:109], v[108:109], v[88:89], v[108:109]
    v_pk_fma_f32 v[102:103], v[6:7], v[72:73], v[110:111]
    v_pk_fma_f32 v[106:107], v[22:23], v[88:89], v[112:113]
    v_pk_fma_f32 v[110:111], v[10:11], v[104:105], v[102:103]
    v_pk_fma_f32 v[112:113], v[26:27], v[108:109], v[106:107]
    v_pk_fma_f32 v[104:105], v[104:105], v[74:75], v[104:105]
    v_pk_fma_f32 v[108:109], v[108:109], v[90:91], v[108:109]
    v_pk_fma_f32 v[102:103], v[102:103], v[74:75], v[110:111]
    v_pk_fma_f32 v[106:107], v[106:107], v[90:91], v[112:113]
    s_cbranch_vccnz K_vb03
    s_waitcnt lgkmcnt(0)
    buffer_load_dwordx4 v[132:133], s[36:39], s48 idxen offen offset:0 sc1 lds
    buffer_load_dwordx4 v[134:135], s[36:39], s49 idxen offen offset:1024 sc1 lds
    buffer_load_dwordx4 v[136:137], s[36:39], s50 idxen offen offset:2048 sc1 lds
    buffer_load_dwordx4 v[138:139], s[36:39], s51 idxen offen offset:3072 sc1 lds
    v_mfma_f32_32x32x8_bf16 v[32:47], v[96:97], v[98:99], v[32:47]
K_vb03:
    v_exp_f32 v76, v12
    v_exp_f32 v77, v13
    v_exp_f32 v92, v28
    v_exp_f32 v93, v29
    v_mfma_f32_32x32x8_bf16 v[48:63], v[96:97], v[100:101], v[48:63]
    v_exp_f32 v78, v14
    v_exp_f32 v79, v15
    v_exp_f32 v94, v30
    v_exp_f32 v95, v31
    v_readlane_b32 s52, v148, s31
    v_add_u32 v143, 0x200, v143
    s_and_b32 s34, s52, 0xffff
    s_add_u32 s31, s31, 2
    s_add_u32 s34, s34, s32
    s_addc_u32 s35, s33, 0
.p2align 3
    v_pk_fma_f32 v[110:111], v[12:13], v[104:105], v[102:103]
    v_pk_fma_f32 v[112:113], v[28:29], v[108:109], v[106:107]
    v_pk_fma_f32 v[104:105], v[104:105], v[76:77], v[104:105]
    v_pk_fma_f32 v[108:109], v[108:109], v[92:93], v[108:109]
    v_pk_fma_f32 v[102:103], v[102:103], v[76:77], v[110:111]
    v_pk_fma_f32 v[106:107], v[106:107], v[92:93], v[112:113]
    v_pk_fma_f32 v[110:111], v[14:15], v[104:105], v[102:103]
    v_pk_fma_f32 v[112:113], v[30:31], v[108:109], v[106:107]
    v_pk_fma_f32 v[104:105], v[104:105], v[78:79], v[104:105]
    v_pk_fma_f32 v[108:109], v[108:109], v[94:95], v[108:109]
    v_pk_fma_f32 v[102:103], v[102:103], v[78:79], v[110:111]
    v_pk_fma_f32 v[106:107], v[106:107], v[94:95], v[112:113]
    v_add_u32 v145, 288, v145
    s_setpc_b64 s[34:35]
.org K_vbase + 4800, 0
    s_setprio 2
    s_branch K_var04
    s_setprio 1
    s_branch K_var04
    s_mov_b64 vcc, -1
    s_branch K_var04
    s_setprio 0
    s_mov_b32 s38, 0
K_var04:
    v_exp_f32 v64, v0
    v_exp_f32 v65, v1
    v_exp_f32 v80, v16
    v_exp_f32 v81, v17
    v_exp_f32 v66, v2
    v_exp_f32 v67, v3
    v_exp_f32 v82, v18
    v_exp_f32 v83, v19
    v_exp_f32 v68, v4
    v_exp_f32 v69, v5
    v_exp_f32 v84, v20
    v_exp_f32 v85, v21
    v_exp_f32 v70, v6
    v_exp_f32 v71, v7
    v_exp_f32 v86, v22
    v_exp_f32 v87, v23
    v_exp_f32 v72, v8
    v_exp_f32 v73, v9
    v_exp_f32 v88, v24
    v_exp_f32 v89, v25
    v_exp_f32 v74, v10
    v_exp_f32 v75, v11
    v_exp_f32 v90, v26
    v_exp_f32 v91, v27
.p2align 3
    v_pk_fma_f32 v[110:111], v[0:1], v[104:105], v[102:103]
    v_pk_fma_f32 v[112:113], v[16:17], v[108:109], v[106:107]
    v_pk_fma_f32 v[104:105], v[104:105], v[64:65], v[104:105]
    v_pk_fma_f32 v[108:109], v[108:109], v[80:81], v[108:109]
    v_pk_fma_f32 v[102:103], v[102:103], v[64:65], v[110:111]
    v_pk_fma_f32 v[106:107], v[106:107], v[80:81], v[112:113]
    v_pk_fma_f32 v[110:111], v[2:3], v[104:105], v[102:103]
    v_pk_fma_f32 v[112:113], v[18:19], v[108:109], v[106:107]
    v_pk_fma_f32 v[104:105], v[104:105], v[66:67], v[104:105]
    v_pk_fma_f32 v[108:109], v[108:109], v[82:83], v[108:109]
    v_pk_fma_f32 v[102:103], v[102:103], v[66:67], v[110:111]
    v_pk_fma_f32 v[106:107], v[106:107], v[82:83], v[112:113]
    v_pk_fma_f32 v[110:111], v[4:5], v[104:105], v[102:103]
    v_pk_fma_f32 v[112:113], v[20:21], v[108:109], v[106:107]
    v_pk_fma_f32 v[104:105], v[104:105], v[68:69], v[104:105]
    v_pk_fma_f32 v[108:109], v[108:109], v[84:85], v[108:109]
    v_pk_fma_f32 v[102:103], v[102:103], v[68:69], v[110:111]
    v_pk_fma_f32 v[106:107], v[106:107], v[84:85], v[112:113]
    v_pk_fma_f32 v[110:111], v[6:7], v[104:105], v[102:103]
    v_pk_fma_f32 v[112:113], v[22:23], v[108:109], v[106:107]
    v_pk_fma_f32 v[104:105], v[104:105], v[70:71], v[104:105]
    v_pk_fma_f32 v[108:109], v[108:109], v[86:87], v[108:109]
    v_pk_fma_f32 v[102:103], v[102:103], v[70:71], v[110:111]
    v_pk_fma_f32 v[106:107], v[106:107], v[86:87], v[112:113]
    s_cbranch_vccnz K_va04
    s_waitcnt vmcnt(0)
    ds_read_b32 v96, v142 offset:64
    ds_read_b32 v97, v142 offset:14144
    ds_read_b32 v98, v143 offset:0
    ds_read_b32 v100, v143 offset:256
    ds_read_b64_tr_b16 v[32:33], v140 offset:0
    ds_read_b64_tr_b16 v[48:49], v140 offset:128
    ds_read_b64_tr_b16 v[34:35], v140 offset:512
    ds_read_b64_tr_b16 v[50:51], v140 offset:640
    ds_read_b64_tr_b16 v[36:37], v140 offset:1024
    ds_read_b64_tr_b16 v[52:53], v140 offset:1152
    ds_read_b64_tr_b16 v[38:39], v140 offset:1536
    ds_read_b64_tr_b16 v[54:55], v140 offset:1664
    ds_read_b64_tr_b16 v[40:41], v140 offset:2048
    ds_read_b64_tr_b16 v[56:57], v140 offset:2176
    ds_read_b64_tr_b16 v[42:43], v140 offset:2560
    ds_read_b64_tr_b16 v[58:59], v140 offset:2688
    ds_read_b64_tr_b16 v[44:45], v140 offset:3072
    ds_read_b64_tr_b16 v[60:61], v140 offset:3200
    ds_read_b64_tr_b16 v[46:47], v140 offset:3584
    ds_read_b64_tr_b16 v[62:63], v140 offset:3712
    ds_read_u16 v132, v141 offset:64
    ds_read_u16 v134, v141 offset:72
    ds_read_u16 v136, v141 offset:80
    ds_read_u16 v138, v141 offset:88
.p2align 3
K_va04:
.p2align 3
    v_rcp_f32 v114, v104
    v_rcp_f32 v115, v105
    v_rcp_f32 v116, v108
    v_rcp_f32 v117, v109
    v_pk_add_f32 v[104:105], v[72:73], 1.0 op_sel_hi:[1,0]
    v_pk_add_f32 v[108:109], v[88:89], 1.0 op_sel_hi:[1,0]
    v_pk_mul_f32 v[118:119], v[102:103], v[114:115]
    v_pk_mul_f32 v[120:121], v[106:107], v[116:117]
    v_min3_f32 v146, v146, v114, v115
    v_min3_f32 v146, v146, v116, v117
    v_add_f32 v118, v118, v119
    v_add_f32 v120, v120, v121
    v_cvt_pk_bf16_f32 v118, v118, v120
    ds_write_b32 v145, v118
    v_pk_fma_f32 v[110:111], v[10:11], v[104:105], v[8:9]
    v_pk_fma_f32 v[112:113], v[26:27], v[108:109], v[24:25]
    v_pk_fma_f32 v[104:105], v[104:105], v[74:75], v[104:105]
    v_pk_fma_f32 v[108:109], v[108:109], v[90:91], v[108:109]
    v_pk_fma_f32 v[102:103], v[8:9], v[74:75], v[110:111]
    v_pk_fma_f32 v[106:107], v[24:25], v[90:91], v[112:113]
    s_cbranch_vccnz K_vb04
    s_waitcnt lgkmcnt(0)
    buffer_load_dwordx4 v[132:133], s[36:39], s48 idxen offen offset:0 sc1 lds
    buffer_load_dwordx4 v[134:135], s[36:39], s49 idxen offen offset:1024 sc1 lds
    buffer_load_dwordx4 v[136:137], s[36:39], s50 idxen offen offset:2048 sc1 lds
    buffer_load_dwordx4 v[138:139], s[36:39], s51 idxen offen offset:3072 sc1 lds
    v_mfma_f32_32x32x8_bf16 v[32:47], v[96:97], v[98:99], v[32:47]
K_vb04:
    v_exp_f32 v76, v12
    v_exp_f32 v77, v13
    v_exp_f32 v92, v28
    v_exp_f32 v93, v29
    v_mfma_f32_32x32x8_bf16 v[48:63], v[96:97], v[100:101], v[48:63]
    v_exp_f32 v78, v14
    v_exp_f32 v79, v15
    v_exp_f32 v94, v30
    v_exp_f32 v95, v31
    v_readlane_b32 s52, v148, s31
    v_add_u32 v143, 0x200, v143
    s_and_b32 s34, s52, 0xffff
    s_add_u32 s31, s31, 2
    s_add_u32 s34, s34, s32
    s_addc_u32 s35, s33, 0
.p2align 3
    v_pk_fma_f32 v[110:111], v[12:13], v[104:105], v[102:103]
    v_pk_fma_f32 v[112:113], v[28:29], v[108:109], v[106:107]
    v_pk_fma_f32 v[104:105], v[104:105], v[76:77], v[104:105]
    v_pk_fma_f32 v[108:109], v[108:109], v[92:93], v[108:109]
    v_pk_fma_f32 v[102:103], v[102:103], v[76:77], v[110:111]
    v_pk_fma_f32 v[106:107], v[106:107], v[92:93], v[112:113]
    v_pk_fma_f32 v[110:111], v[14:15], v[104:105], v[102:103]
    v_pk_fma_f32 v[112:113], v[30:31], v[108:109], v[106:107]
    v_pk_fma_f32 v[104:105], v[104:105], v[78:79], v[104:105]
    v_pk_fma_f32 v[108:109], v[108:109], v[94:95], v[108:109]
    v_pk_fma_f32 v[102:103], v[102:103], v[78:79], v[110:111]
    v_pk_fma_f32 v[106:107], v[106:107], v[94:95], v[112:113]
    v_add_u32 v145, 288, v145
    s_setpc_b64 s[34:35]
.org K_vbase + 5760, 0
    s_setprio 2
    s_branch K_var05
    s_setprio 1
    s_branch K_var05
    s_mov_b64 vcc, -1
    s_branch K_var05
    s_setprio 0
    s_mov_b32 s38, 0
K_var05:
    v_exp_f32 v64, v0
    v_exp_f32 v65, v1
    v_exp_f32 v80, v16
    v_exp_f32 v81, v17
    v_exp_f32 v66, v2
    v_exp_f32 v67, v3
    v_exp_f32 v82, v18
    v_exp_f32 v83, v19
    v_exp_f32 v68, v4
    v_exp_f32 v69, v5
    v_exp_f32 v84, v20
    v_exp_f32 v85, v21
    v_exp_f32 v70, v6
    v_exp_f32 v71, v7
    v_exp_f32 v86, v22
    v_exp_f32 v87, v23
    v_exp_f32 v72, v8
    v_exp_f32 v73, v9
    v_exp_f32 v88, v24
    v_exp_f32 v89, v25
    v_exp_f32 v74, v10
    v_exp_f32 v75, v11
    v_exp_f32 v90, v26
    v_exp_f32 v91, v27
.p2align 3
    v_pk_fma_f32 v[110:111], v[0:1], v[104:105], v[102:103]
    v_pk_fma_f32 v[112:113], v[16:17], v[108:109], v[106:107]
    v_pk_fma_f32 v[104:105], v[104:105], v[64:65], v[104:105]
    v_pk_fma_f32 v[108:109], v[108:109], v[80:81], v[108:109]
    v_pk_fma_f32 v[102:103], v[102:103], v[64:65], v[110:111]
    v_pk_fma_f32 v[106:107], v[106:107], v[80:81], v[112:113]
    v_pk_fma_f32 v[110:111], v[2:3], v[104:105], v[102:103]
    v_pk_fma_f32 v[112:113], v[18:19], v[108:109], v[106:107]
    v_pk_fma_f32 v[104:105], v[104:105], v[66:67], v[104:105]
    v_pk_fma_f32 v[108:109], v[108:109], v[82:83], v[108:109]
    v_pk_fma_f32 v[102:103], v[102:103], v[66:67], v[110:111]
    v_pk_fma_f32 v[106:107], v[106:107], v[82:83], v[112:113]
    v_pk_fma_f32 v[110:111], v[4:5], v[104:105], v[102:103]
    v_pk_fma_f32 v[112:113], v[20:21], v[108:109], v[106:107]
    v_pk_fma_f32 v[104:105], v[104:105], v[68:69], v[104:105]
    v_pk_fma_f32 v[108:109], v[108:109], v[84:85], v[108:109]
    v_pk_fma_f32 v[102:103], v[102:103], v[68:69], v[110:111]
    v_pk_fma_f32 v[106:107], v[106:107], v[84:85], v[112:113]
    v_pk_fma_f32 v[110:111], v[6:7], v[104:105], v[102:103]
    v_pk_fma_f32 v[112:113], v[22:23], v[108:109], v[106:107]
    v_pk_fma_f32 v[104:105], v[104:105], v[70:71], v[104:105]
    v_pk_fma_f32 v[108:109], v[108:109], v[86:87], v[108:109]
    v_pk_fma_f32 v[102:103], v[102:103], v[70:71], v[110:111]
    v_pk_fma_f32 v[106:107], v[106:107], v[86:87], v[112:113]
    s_cbranch_vccnz K_va05
    s_waitcnt vmcnt(0)
    ds_read_b32 v96, v142 offset:64
    ds_read_b32 v97, v142 offset:14144
    ds_read_b32 v98, v143 offset:0
    ds_read_b32 v100, v143 offset:256
    ds_read_b64_tr_b16 v[32:33], v140 offset:0
    ds_read_b64_tr_b16 v[48:49], v140 offset:128
    ds_read_b64_tr_b16 v[34:35], v140 offset:512
    ds_read_b64_tr_b16 v[50:51], v140 offset:640
    ds_read_b64_tr_b16 v[36:37], v140 offset:1024
    ds_read_b64_tr_b16 v[52:53], v140 offset:1152
    ds_read_b64_tr_b16 v[38:39], v140 offset:1536
    ds_read_b64_tr_b16 v[54:55], v140 offset:1664
    ds_read_b64_tr_b16 v[40:41], v140 offset:2048
    ds_read_b64_tr_b16 v[56:57], v140 offset:2176
    ds_read_b64_tr_b16 v[42:43], v140 offset:2560
    ds_read_b64_tr_b16 v[58:59], v140 offset:2688
    ds_read_b64_tr_b16 v[44:45], v140 offset:3072
    ds_read_b64_tr_b16 v[60:61], v140 offset:3200
    ds_read_b64_tr_b16 v[46:47], v140 offset:3584
    ds_read_b64_tr_b16 v[62:63], v140 offset:3712
    ds_read_u16 v132, v141 offset:64
    ds_read_u16 v134, v141 offset:72
    ds_read_u16 v136, v141 offset:80
    ds_read_u16 v138, v141 offset:88
.p2align 3
K_va05:
.p2align 3
    v_pk_fma_f32 v[110:111], v[8:9], v[104:105], v[102:103]
    v_pk_fma_f32 v[112:113], v[24:25], v[108:109], v[106:107]
    v_pk_fma_f32 v[104:105], v[104:105], v[72:73], v[104:105]
    v_pk_fma_f32 v[108:109], v[108:109], v[88:89], v[108:109]
    v_pk_fma_f32 v[102:103], v[102:103], v[72:73], v[110:111]
    v_pk_fma_f32 v[106:107], v[106:107], v[88:89], v[112:113]
    v_rcp_f32 v114, v104
    v_rcp_f32 v115, v105
    v_rcp_f32 v116, v108
    v_rcp_f32 v117, v109
    v_pk_add_f32 v[104:105], v[74:75], 1.0 op_sel_hi:[1,0]
    v_pk_add_f32 v[108:109], v[90:91], 1.0 op_sel_hi:[1,0]
    v_pk_mul_f32 v[118:119], v[102:103], v[114:115]
    v_pk_mul_f32 v[120:121], v[106:107], v[116:117]
    v_min3_f32 v146, v146, v114, v115
    v_min3_f32 v146, v146, v116, v117
    v_add_f32 v118, v118, v119
    v_add_f32 v120, v120, v121
    v_cvt_pk_bf16_f32 v118, v118, v120
    ds_write_b32 v145, v118
    s_cbranch_vccnz K_vb05
    s_waitcnt lgkmcnt(0)
    buffer_load_dwordx4 v[132:133], s[36:39], s48 idxen offen offset:0 sc1 lds
    buffer_load_dwordx4 v[134:135], s[36:39], s49 idxen offen offset:1024 sc1 lds
    buffer_load_dwordx4 v[136:137], s[36:39], s50 idxen offen offset:2048 sc1 lds
    buffer_load_dwordx4 v[138:139], s[36:39], s51 idxen offen offset:3072 sc1 lds
    v_mfma_f32_32x32x8_bf16 v[32:47], v[96:97], v[98:99], v[32:47]
K_vb05:
    v_exp_f32 v76, v12
    v_exp_f32 v77, v13
    v_exp_f32 v92, v28
    v_exp_f32 v93, v29
    v_mfma_f32_32x32x8_bf16 v[48:63], v[96:97], v[100:101], v[48:63]
    v_exp_f32 v78, v14
    v_exp_f32 v79, v15
    v_exp_f32 v94, v30
    v_exp_f32 v95, v31
    v_readlane_b32 s52, v148, s31
    v_add_u32 v143, 0x200, v143
    s_and_b32 s34, s52, 0xffff
    s_add_u32 s31, s31, 2
    s_add_u32 s34, s34, s32
    s_addc_u32 s35, s33, 0
.p2align 3
    v_pk_fma_f32 v[110:111], v[12:13], v[104:105], v[10:11]
    v_pk_fma_f32 v[112:113], v[28:29], v[108:109], v[26:27]
    v_pk_fma_f32 v[104:105], v[104:105], v[76:77], v[104:105]
    v_pk_fma_f32 v[108:109], v[108:109], v[92:93], v[108:109]
    v_pk_fma_f32 v[102:103], v[10:11], v[76:77], v[110:111]
    v_pk_fma_f32 v[106:107], v[26:27], v[92:93], v[112:113]
    v_pk_fma_f32 v[110:111], v[14:15], v[104:105], v[102:103]
    v_pk_fma_f32 v[112:113], v[30:31], v[108:109], v[106:107]
    v_pk_fma_f32 v[104:105], v[104:105], v[78:79], v[104:105]
    v_pk_fma_f32 v[108:109], v[108:109], v[94:95], v[108:109]
    v_pk_fma_f32 v[102:103], v[102:103], v[78:79], v[110:111]
    v_pk_fma_f32 v[106:107], v[106:107], v[94:95], v[112:113]
    v_add_u32 v145, 288, v145
    s_setpc_b64 s[34:35]
.org K_vbase + 6720, 0
    s_setprio 2
    s_branch K_var06
    s_setprio 1
    s_branch K_var06
    s_mov_b64 vcc, -1
    s_branch K_var06
    s_setprio 0
    s_mov_b32 s38, 0
K_var06:
    v_exp_f32 v64, v0
    v_exp_f32 v65, v1
    v_exp_f32 v80, v16
    v_exp_f32 v81, v17
    v_exp_f32 v66, v2
    v_exp_f32 v67, v3
    v_exp_f32 v82, v18
    v_exp_f32 v83, v19
    v_exp_f32 v68, v4
    v_exp_f32 v69, v5
    v_exp_f32 v84, v20
    v_exp_f32 v85, v21
    v_exp_f32 v70, v6
    v_exp_f32 v71, v7
    v_exp_f32 v86, v22
    v_exp_f32 v87, v23
    v_exp_f32 v72, v8
    v_exp_f32 v73, v9
    v_exp_f32 v88, v24
    v_exp_f32 v89, v25
    v_exp_f32 v74, v10
    v_exp_f32 v75, v11
    v_exp_f32 v90, v26
    v_exp_f32 v91, v27
.p2align 3
    v_pk_fma_f32 v[110:111], v[0:1], v[104:105], v[102:103]
    v_pk_fma_f32 v[112:113], v[16:17], v[108:109], v[106:107]
    v_pk_fma_f32 v[104:105], v[104:105], v[64:65], v[104:105]
    v_pk_fma_f32 v[108:109], v[108:109], v[80:81], v[108:109]
    v_pk_fma_f32 v[102:103], v[102:103], v[64:65], v[110:111]
    v_pk_fma_f32 v[106:107], v[106:107], v[80:81], v[112:113]
    v_pk_fma_f32 v[110:111], v[2:3], v[104:105], v[102:103]
    v_pk_fma_f32 v[112:113], v[18:19], v[108:109], v[106:107]
    v_pk_fma_f32 v[104:105], v[104:105], v[66:67], v[104:105]
    v_pk_fma_f32 v[108:109], v[108:109], v[82:83], v[108:109]
    v_pk_fma_f32 v[102:103], v[102:103], v[66:67], v[110:111]
    v_pk_fma_f32 v[106:107], v[106:107], v[82:83], v[112:113]
    v_pk_fma_f32 v[110:111], v[4:5], v[104:105], v[102:103]
    v_pk_fma_f32 v[112:113], v[20:21], v[108:109], v[106:107]
    v_pk_fma_f32 v[104:105], v[104:105], v[68:69], v[104:105]
    v_pk_fma_f32 v[108:109], v[108:109], v[84:85], v[108:109]
    v_pk_fma_f32 v[102:103], v[102:103], v[68:69], v[110:111]
    v_pk_fma_f32 v[106:107], v[106:107], v[84:85], v[112:113]
    v_pk_fma_f32 v[110:111], v[6:7], v[104:105], v[102:103]
    v_pk_fma_f32 v[112:113], v[22:23], v[108:109], v[106:107]
    v_pk_fma_f32 v[104:105], v[104:105], v[70:71], v[104:105]
    v_pk_fma_f32 v[108:109], v[108:109], v[86:87], v[108:109]
    v_pk_fma_f32 v[102:103], v[102:103], v[70:71], v[110:111]
    v_pk_fma_f32 v[106:107], v[106:107], v[86:87], v[112:113]
    s_cbranch_vccnz K_va06
    s_waitcnt vmcnt(0)
    ds_read_b32 v96, v142 offset:64
    ds_read_b32 v97, v142 offset:14144
    ds_read_b32 v98, v143 offset:0
    ds_read_b32 v100, v143 offset:256
    ds_read_b64_tr_b16 v[32:33], v140 offset:0
    ds_read_b64_tr_b16 v[48:49], v140 offset:128
    ds_read_b64_tr_b16 v[34:35], v140 offset:512
    ds_read_b64_tr_b16 v[50:51], v140 offset:640
    ds_read_b64_tr_b16 v[36:37], v140 offset:1024
    ds_read_b64_tr_b16 v[52:53], v140 offset:1152
    ds_read_b64_tr_b16 v[38:39], v140 offset:1536
    ds_read_b64_tr_b16 v[54:55], v140 offset:1664
    ds_read_b64_tr_b16 v[40:41], v140 offset:2048
    ds_read_b64_tr_b16 v[56:57], v140 offset:2176
    ds_read_b64_tr_b16 v[42:43], v140 offset:2560
    ds_read_b64_tr_b16 v[58:59], v140 offset:2688
    ds_read_b64_tr_b16 v[44:45], v140 offset:3072
    ds_read_b64_tr_b16 v[60:61], v140 offset:3200
    ds_read_b64_tr_b16 v[46:47], v140 offset:3584
    ds_read_b64_tr_b16 v[62:63], v140 offset:3712
    ds_read_u16 v132, v141 offset:64
    ds_read_u16 v134, v141 offset:72
    ds_read_u16 v136, v141 offset:80
    ds_read_u16 v138, v141 offset:88
.p2align 3
K_va06:
.p2align 3
    v_pk_fma_f32 v[110:111], v[8:9], v[104:105], v[102:103]
    v_pk_fma_f32 v[112:113], v[24:25], v[108:109], v[106:107]
    v_pk_fma_f32 v[104:105], v[104:105], v[72:73], v[104:105]
    v_pk_fma_f32 v[108:109], v[108:109], v[88:89], v[108:109]
    v_pk_fma_f32 v[102:103], v[102:103], v[72:73], v[110:111]
    v_pk_fma_f32 v[106:107], v[106:107], v[88:89], v[112:113]
    v_pk_fma_f32 v[110:111], v[10:11], v[104:105], v[102:103]
    v_pk_fma_f32 v[112:113], v[26:27], v[108:109], v[106:107]
    v_pk_fma_f32 v[104:105], v[104:105], v[74:75], v[104:105]
    v_pk_fma_f32 v[108:109], v[108:109], v[90:91], v[108:109]
    v_pk_fma_f32 v[102:103], v[102:103], v[74:75], v[110:111]
    v_pk_fma_f32 v[106:107], v[106:107], v[90:91], v[112:113]
    s_cbranch_vccnz K_vb06
    s_waitcnt lgkmcnt(0)
    buffer_load_dwordx4 v[132:133], s[36:39], s48 idxen offen offset:0 sc1 lds
    buffer_load_dwordx4 v[134:135], s[36:39], s49 idxen offen offset:1024 sc1 lds
    buffer_load_dwordx4 v[136:137], s[36:39], s50 idxen offen offset:2048 sc1 lds
    buffer_load_dwordx4 v[138:139], s[36:39], s51 idxen offen offset:3072 sc1 lds
    v_mfma_f32_32x32x8_bf16 v[32:47], v[96:97], v[98:99], v[32:47]
K_vb06:
    v_exp_f32 v76, v12
    v_exp_f32 v77, v13
    v_exp_f32 v92, v28
    v_exp_f32 v93, v29
    v_mfma_f32_32x32x8_bf16 v[48:63], v[96:97], v[100:101], v[48:63]
    v_exp_f32 v78, v14
    v_exp_f32 v79, v15
    v_exp_f32 v94, v30
    v_exp_f32 v95, v31
    v_readlane_b32 s52, v148, s31
    v_add_u32 v143, 0x200, v143
    s_and_b32 s34, s52, 0xffff
    s_add_u32 s31, s31, 2
    s_add_u32 s34, s34, s32
    s_addc_u32 s35, s33, 0
.p2align 3
    v_rcp_f32 v114, v104
    v_rcp_f32 v115, v105
    v_rcp_f32 v116, v108
    v_rcp_f32 v117, v109
    v_pk_add_f32 v[104:105], v[76:77], 1.0 op_sel_hi:[1,0]
    v_pk_add_f32 v[108:109], v[92:93], 1.0 op_sel_hi:[1,0]
    v_pk_mul_f32 v[118:119], v[102:103], v[114:115]
    v_pk_mul_f32 v[120:121], v[106:107], v[116:117]
    v_min3_f32 v146, v146, v114, v115
    v_min3_f32 v146, v146, v116, v117
    v_add_f32 v118, v118, v119
    v_add_f32 v120, v120, v121
    v_cvt_pk_bf16_f32 v118, v118, v120
    ds_write_b32 v145, v118
    v_pk_fma_f32 v[110:111], v[14:15], v[104:105], v[12:13]
    v_pk_fma_f32 v[112:113], v[30:31], v[108:109], v[28:29]
    v_pk_fma_f32 v[104:105], v[104:105], v[78:79], v[104:105]
    v_pk_fma_f32 v[108:109], v[108:109], v[94:95], v[108:109]
    v_pk_fma_f32 v[102:103], v[12:13], v[78:79], v[110:111]
    v_pk_fma_f32 v[106:107], v[28:29], v[94:95], v[112:113]
    v_add_u32 v145, 288, v145
    s_setpc_b64 s[34:35]
.org K_vbase + 7680, 0
    s_setprio 2
    s_branch K_var07
    s_setprio 1
    s_branch K_var07
    s_mov_b64 vcc, -1
    s_branch K_var07
    s_setprio 0
    s_mov_b32 s38, 0
K_var07:
    v_exp_f32 v64, v0
    v_exp_f32 v65, v1
    v_exp_f32 v80, v16
    v_exp_f32 v81, v17
    v_exp_f32 v66, v2
    v_exp_f32 v67, v3
    v_exp_f32 v82, v18
    v_exp_f32 v83, v19
    v_exp_f32 v68, v4
    v_exp_f32 v69, v5
    v_exp_f32 v84, v20
    v_exp_f32 v85, v21
    v_exp_f32 v70, v6
    v_exp_f32 v71, v7
    v_exp_f32 v86, v22
    v_exp_f32 v87, v23
    v_exp_f32 v72, v8
    v_exp_f32 v73, v9
    v_exp_f32 v88, v24
    v_exp_f32 v89, v25
    v_exp_f32 v74, v10
    v_exp_f32 v75, v11
    v_exp_f32 v90, v26
    v_exp_f32 v91, v27
.p2align 3
    v_pk_fma_f32 v[110:111], v[0:1], v[104:105], v[102:103]
    v_pk_fma_f32 v[112:113], v[16:17], v[108:109], v[106:107]
    v_pk_fma_f32 v[104:105], v[104:105], v[64:65], v[104:105]
    v_pk_fma_f32 v[108:109], v[108:109], v[80:81], v[108:109]
    v_pk_fma_f32 v[102:103], v[102:103], v[64:65], v[110:111]
    v_pk_fma_f32 v[106:107], v[106:107], v[80:81], v[112:113]
    v_pk_fma_f32 v[110:111], v[2:3], v[104:105], v[102:103]
    v_pk_fma_f32 v[112:113], v[18:19], v[108:109], v[106:107]
    v_pk_fma_f32 v[104:105], v[104:105], v[66:67], v[104:105]
    v_pk_fma_f32 v[108:109], v[108:109], v[82:83], v[108:109]
    v_pk_fma_f32 v[102:103], v[102:103], v[66:67], v[110:111]
    v_pk_fma_f32 v[106:107], v[106:107], v[82:83], v[112:113]
    v_pk_fma_f32 v[110:111], v[4:5], v[104:105], v[102:103]
    v_pk_fma_f32 v[112:113], v[20:21], v[108:109], v[106:107]
    v_pk_fma_f32 v[104:105], v[104:105], v[68:69], v[104:105]
    v_pk_fma_f32 v[108:109], v[108:109], v[84:85], v[108:109]
    v_pk_fma_f32 v[102:103], v[102:103], v[68:69], v[110:111]
    v_pk_fma_f32 v[106:107], v[106:107], v[84:85], v[112:113]
    v_pk_fma_f32 v[110:111], v[6:7], v[104:105], v[102:103]
    v_pk_fma_f32 v[112:113], v[22:23], v[108:109], v[106:107]
    v_pk_fma_f32 v[104:105], v[104:105], v[70:71], v[104:105]
    v_pk_fma_f32 v[108:109], v[108:109], v[86:87], v[108:109]
    v_pk_fma_f32 v[102:103], v[102:103], v[70:71], v[110:111]
    v_pk_fma_f32 v[106:107], v[106:107], v[86:87], v[112:113]
    s_cbranch_vccnz K_va07
    s_waitcnt vmcnt(0)
    ds_read_b32 v96, v142 offset:64
    ds_read_b32 v97, v142 offset:14144
    ds_read_b32 v98, v143 offset:0
    ds_read_b32 v100, v143 offset:256
    ds_read_b64_tr_b16 v[32:33], v140 offset:0
    ds_read_b64_tr_b16 v[48:49], v140 offset:128
    ds_read_b64_tr_b16 v[34:35], v140 offset:512
    ds_read_b64_tr_b16 v[50:51], v140 offset:640
    ds_read_b64_tr_b16 v[36:37], v140 offset:1024
    ds_read_b64_tr_b16 v[52:53], v140 offset:1152
    ds_read_b64_tr_b16 v[38:39], v140 offset:1536
    ds_read_b64_tr_b16 v[54:55], v140 offset:1664
    ds_read_b64_tr_b16 v[40:41], v140 offset:2048
    ds_read_b64_tr_b16 v[56:57], v140 offset:2176
    ds_read_b64_tr_b16 v[42:43], v140 offset:2560
    ds_read_b64_tr_b16 v[58:59], v140 offset:2688
    ds_read_b64_tr_b16 v[44:45], v140 offset:3072
    ds_read_b64_tr_b16 v[60:61], v140 offset:3200
    ds_read_b64_tr_b16 v[46:47], v140 offset:3584
    ds_read_b64_tr_b16 v[62:63], v140 offset:3712
    ds_read_u16 v132, v141 offset:64
    ds_read_u16 v134, v141 offset:72
    ds_read_u16 v136, v141 offset:80
    ds_read_u16 v138, v141 offset:88
.p2align 3
K_va07:
.p2align 3
    v_pk_fma_f32 v[110:111], v[8:9], v[104:105], v[102:103]
    v_pk_fma_f32 v[112:113], v[24:25], v[108:109], v[106:107]
    v_pk_fma_f32 v[104:105], v[104:105], v[72:73], v[104:105]
    v_pk_fma_f32 v[108:109], v[108:109], v[88:89], v[108:109]
    v_pk_fma_f32 v[102:103], v[102:103], v[72:73], v[110:111]
    v_pk_fma_f32 v[106:107], v[106:107], v[88:89], v[112:113]
    v_pk_fma_f32 v[110:111], v[10:11], v[104:105], v[102:103]
    v_pk_fma_f32 v[112:113], v[26:27], v[108:109], v[106:107]
    v_pk_fma_f32 v[104:105], v[104:105], v[74:75], v[104:105]
    v_pk_fma_f32 v[108:109], v[108:109], v[90:91], v[108:109]
    v_pk_fma_f32 v[102:103], v[102:103], v[74:75], v[110:111]
    v_pk_fma_f32 v[106:107], v[106:107], v[90:91], v[112:113]
    s_cbranch_vccnz K_vb07
    s_waitcnt lgkmcnt(0)
    buffer_load_dwordx4 v[132:133], s[36:39], s48 idxen offen offset:0 sc1 lds
    buffer_load_dwordx4 v[134:135], s[36:39], s49 idxen offen offset:1024 sc1 lds
    buffer_load_dwordx4 v[136:137], s[36:39], s50 idxen offen offset:2048 sc1 lds
    buffer_load_dwordx4 v[138:139], s[36:39], s51 idxen offen offset:3072 sc1 lds
    v_mfma_f32_32x32x8_bf16 v[32:47], v[96:97], v[98:99], v[32:47]
K_vb07:
    v_exp_f32 v76, v12
    v_exp_f32 v77, v13
    v_exp_f32 v92, v28
    v_exp_f32 v93, v29
    v_mfma_f32_32x32x8_bf16 v[48:63], v[96:97], v[100:101], v[48:63]
    v_exp_f32 v78, v14
    v_exp_f32 v79, v15
    v_exp_f32 v94, v30
    v_exp_f32 v95, v31
    v_readlane_b32 s52, v148, s31
    v_add_u32 v143, 0x200, v143
    s_and_b32 s34, s52, 0xffff
    s_add_u32 s31, s31, 2
    s_add_u32 s34, s34, s32
    s_addc_u32 s35, s33, 0
.p2align 3
    v_pk_fma_f32 v[110:111], v[12:13], v[104:105], v[102:103]
    v_pk_fma_f32 v[112:113], v[28:29], v[108:109], v[106:107]
    v_pk_fma_f32 v[104:105], v[104:105], v[76:77], v[104:105]
    v_pk_fma_f32 v[108:109], v[108:109], v[92:93], v[108:109]
    v_pk_fma_f32 v[102:103], v[102:103], v[76:77], v[110:111]
    v_pk_fma_f32 v[106:107], v[106:107], v[92:93], v[112:113]
    v_rcp_f32 v114, v104
    v_rcp_f32 v115, v105
    v_rcp_f32 v116, v108
    v_rcp_f32 v117, v109
    v_pk_add_f32 v[104:105], v[78:79], 1.0 op_sel_hi:[1,0]
    v_pk_add_f32 v[108:109], v[94:95], 1.0 op_sel_hi:[1,0]
    v_pk_mul_f32 v[118:119], v[102:103], v[114:115]
    v_pk_mul_f32 v[120:121], v[106:107], v[116:117]
    v_min3_f32 v146, v146, v114, v115
    v_min3_f32 v146, v146, v116, v117
    v_add_f32 v118, v118, v119
    v_add_f32 v120, v120, v121
    v_cvt_pk_bf16_f32 v118, v118, v120
    ds_write_b32 v145, v118
    v_pk_mov_b32 v[102:103], v[14:15], v[14:15] op_sel:[0,1]
    v_pk_mov_b32 v[106:107], v[30:31], v[30:31] op_sel:[0,1]
    v_add_u32 v145, 288, v145
    s_setpc_b64 s[34:35]
.org K_vbase + 8640, 0
    s_setprio 2
    s_branch K_var1N
    s_setprio 1
    s_branch K_var1N
    s_mov_b64 vcc, -1
    s_branch K_var1N
    s_setprio 0
    s_mov_b32 s38, 0
K_var1N:
    v_exp_f32 v64, v32
    v_exp_f32 v65, v33
    v_exp_f32 v80, v48
    v_exp_f32 v81, v49
    v_exp_f32 v66, v34
    v_exp_f32 v67, v35
    v_exp_f32 v82, v50
    v_exp_f32 v83, v51
    v_exp_f32 v68, v36
    v_exp_f32 v69, v37
    v_exp_f32 v84, v52
    v_exp_f32 v85, v53
    v_exp_f32 v70, v38
    v_exp_f32 v71, v39
    v_exp_f32 v86, v54
    v_exp_f32 v87, v55
    v_exp_f32 v72, v40
    v_exp_f32 v73, v41
    v_exp_f32 v88, v56
    v_exp_f32 v89, v57
    v_exp_f32 v74, v42
    v_exp_f32 v75, v43
    v_exp_f32 v90, v58
    v_exp_f32 v91, v59
.p2align 3
    v_pk_fma_f32 v[110:111], v[32:33], v[104:105], v[102:103]
    v_pk_fma_f32 v[112:113], v[48:49], v[108:109], v[106:107]
    v_pk_fma_f32 v[104:105], v[104:105], v[64:65], v[104:105]
    v_pk_fma_f32 v[108:109], v[108:109], v[80:81], v[108:109]
    v_pk_fma_f32 v[102:103], v[102:103], v[64:65], v[110:111]
    v_pk_fma_f32 v[106:107], v[106:107], v[80:81], v[112:113]
    v_pk_fma_f32 v[110:111], v[34:35], v[104:105], v[102:103]
    v_pk_fma_f32 v[112:113], v[50:51], v[108:109], v[106:107]
    v_pk_fma_f32 v[104:105], v[104:105], v[66:67], v[104:105]
    v_pk_fma_f32 v[108:109], v[108:109], v[82:83], v[108:109]
    v_pk_fma_f32 v[102:103], v[102:103], v[66:67], v[110:111]
    v_pk_fma_f32 v[106:107], v[106:107], v[82:83], v[112:113]
    v_pk_fma_f32 v[110:111], v[36:37], v[104:105], v[102:103]
    v_pk_fma_f32 v[112:113], v[52:53], v[108:109], v[106:107]
    v_pk_fma_f32 v[104:105], v[104:105], v[68:69], v[104:105]
    v_pk_fma_f32 v[108:109], v[108:109], v[84:85], v[108:109]
    v_pk_fma_f32 v[102:103], v[102:103], v[68:69], v[110:111]
    v_pk_fma_f32 v[106:107], v[106:107], v[84:85], v[112:113]
    v_pk_fma_f32 v[110:111], v[38:39], v[104:105], v[102:103]
    v_pk_fma_f32 v[112:113], v[54:55], v[108:109], v[106:107]
    v_pk_fma_f32 v[104:105], v[104:105], v[70:71], v[104:105]
    v_pk_fma_f32 v[108:109], v[108:109], v[86:87], v[108:109]
    v_pk_fma_f32 v[102:103], v[102:103], v[70:71], v[110:111]
    v_pk_fma_f32 v[106:107], v[106:107], v[86:87], v[112:113]
    s_cbranch_vccnz K_va1N
    s_waitcnt vmcnt(0)
    ds_read_b32 v96, v142 offset:128
    ds_read_b32 v97, v142 offset:14208
    ds_read_b64_tr_b16 v[0:1], v140 offset:0
    ds_read_b64_tr_b16 v[16:17], v140 offset:128
    ds_read_b64_tr_b16 v[2:3], v140 offset:512
    ds_read_b64_tr_b16 v[18:19], v140 offset:640
    ds_read_b64_tr_b16 v[4:5], v140 offset:1024
    ds_read_b64_tr_b16 v[20:21], v140 offset:1152
    ds_read_b64_tr_b16 v[6:7], v140 offset:1536
    ds_read_b64_tr_b16 v[22:23], v140 offset:1664
    ds_read_b64_tr_b16 v[8:9], v140 offset:2048
    ds_read_b64_tr_b16 v[24:25], v140 offset:2176
    ds_read_b64_tr_b16 v[10:11], v140 offset:2560
    ds_read_b64_tr_b16 v[26:27], v140 offset:2688
    ds_read_b64_tr_b16 v[12:13], v140 offset:3072
    ds_read_b64_tr_b16 v[28:29], v140 offset:3200
    ds_read_b64_tr_b16 v[14:15], v140 offset:3584
    ds_read_b64_tr_b16 v[30:31], v140 offset:3712
    ds_read_u16 v132, v141 offset:96
    ds_read_u16 v134, v141 offset:104
    ds_read_u16 v136, v141 offset:112
    ds_read_u16 v138, v141 offset:120
.p2align 3
K_va1N:
.p2align 3
    v_pk_fma_f32 v[110:111], v[40:41], v[104:105], v[102:103]
    v_pk_fma_f32 v[112:113], v[56:57], v[108:109], v[106:107]
    v_pk_fma_f32 v[104:105], v[104:105], v[72:73], v[104:105]
    v_pk_fma_f32 v[108:109], v[108:109], v[88:89], v[108:109]
    v_pk_fma_f32 v[102:103], v[102:103], v[72:73], v[110:111]
    v_pk_fma_f32 v[106:107], v[106:107], v[88:89], v[112:113]
    v_pk_fma_f32 v[110:111], v[42:43], v[104:105], v[102:103]
    v_pk_fma_f32 v[112:113], v[58:59], v[108:109], v[106:107]
    v_pk_fma_f32 v[104:105], v[104:105], v[74:75], v[104:105]
    v_pk_fma_f32 v[108:109], v[108:109], v[90:91], v[108:109]
    v_pk_fma_f32 v[102:103], v[102:103], v[74:75], v[110:111]
    v_pk_fma_f32 v[106:107], v[106:107], v[90:91], v[112:113]
    s_cbranch_vccnz K_vb1N
    s_waitcnt lgkmcnt(0)
    buffer_load_dwordx4 v[132:133], s[36:39], s48 idxen offen offset:0 sc1 lds
    buffer_load_dwordx4 v[134:135], s[36:39], s49 idxen offen offset:1024 sc1 lds
    buffer_load_dwordx4 v[136:137], s[36:39], s50 idxen offen offset:2048 sc1 lds
    buffer_load_dwordx4 v[138:139], s[36:39], s51 idxen offen offset:3072 sc1 lds
    v_mfma_f32_32x32x8_bf16 v[0:15], v[96:97], v[98:99], v[0:15]
K_vb1N:
    v_exp_f32 v76, v44
    v_exp_f32 v77, v45
    v_exp_f32 v92, v60
    v_exp_f32 v93, v61
    v_mfma_f32_32x32x8_bf16 v[16:31], v[96:97], v[100:101], v[16:31]
    v_exp_f32 v78, v46
    v_exp_f32 v79, v47
    v_exp_f32 v94, v62
    v_exp_f32 v95, v63
    v_add_u32 v142, v144, v142
    v_add_u32 v141, 64, v141
    s_lshr_b32 s34, s52, 16
    s_add_u32 s34, s34, s32
    s_addc_u32 s35, s33, 0
.p2align 3
    v_pk_fma_f32 v[110:111], v[44:45], v[104:105], v[102:103]
    v_pk_fma_f32 v[112:113], v[60:61], v[108:109], v[106:107]
    v_pk_fma_f32 v[104:105], v[104:105], v[76:77], v[104:105]
    v_pk_fma_f32 v[108:109], v[108:109], v[92:93], v[108:109]
    v_pk_fma_f32 v[102:103], v[102:103], v[76:77], v[110:111]
    v_pk_fma_f32 v[106:107], v[106:107], v[92:93], v[112:113]
    v_pk_fma_f32 v[110:111], v[46:47], v[104:105], v[102:103]
    v_pk_fma_f32 v[112:113], v[62:63], v[108:109], v[106:107]
    v_pk_fma_f32 v[104:105], v[104:105], v[78:79], v[104:105]
    v_pk_fma_f32 v[108:109], v[108:109], v[94:95], v[108:109]
    v_pk_fma_f32 v[102:103], v[102:103], v[78:79], v[110:111]
    v_pk_fma_f32 v[106:107], v[106:107], v[94:95], v[112:113]
    s_setpc_b64 s[34:35]
.org K_vbase + 9600, 0
    s_setprio 2
    s_branch K_var10
    s_setprio 1
    s_branch K_var10
    s_mov_b64 vcc, -1
    s_branch K_var10
    s_setprio 0
    s_mov_b32 s38, 0
K_var10:
    v_exp_f32 v64, v32
    v_exp_f32 v65, v33
    v_exp_f32 v80, v48
    v_exp_f32 v81, v49
    v_exp_f32 v66, v34
    v_exp_f32 v67, v35
    v_exp_f32 v82, v50
    v_exp_f32 v83, v51
    v_exp_f32 v68, v36
    v_exp_f32 v69, v37
    v_exp_f32 v84, v52
    v_exp_f32 v85, v53
    v_exp_f32 v70, v38
    v_exp_f32 v71, v39
    v_exp_f32 v86, v54
    v_exp_f32 v87, v55
    v_exp_f32 v72, v40
    v_exp_f32 v73, v41
    v_exp_f32 v88, v56
    v_exp_f32 v89, v57
    v_exp_f32 v74, v42
    v_exp_f32 v75, v43
    v_exp_f32 v90, v58
    v_exp_f32 v91, v59
.p2align 3
    v_rcp_f32 v114, v104
    v_rcp_f32 v115, v105
    v_rcp_f32 v116, v108
    v_rcp_f32 v117, v109
    v_pk_add_f32 v[104:105], v[64:65], 1.0 op_sel_hi:[1,0]
    v_pk_add_f32 v[108:109], v[80:81], 1.0 op_sel_hi:[1,0]
    v_pk_mul_f32 v[118:119], v[102:103], v[114:115]
    v_pk_mul_f32 v[120:121], v[106:107], v[116:117]
    v_min3_f32 v146, v146, v114, v115
    v_min3_f32 v146, v146, v116, v117
    v_add_f32 v118, v118, v119
    v_add_f32 v120, v120, v121
    v_cvt_pk_bf16_f32 v118, v118, v120
    ds_write_b32 v145, v118
    v_pk_fma_f32 v[110:111], v[34:35], v[104:105], v[32:33]
    v_pk_fma_f32 v[112:113], v[50:51], v[108:109], v[48:49]
    v_pk_fma_f32 v[104:105], v[104:105], v[66:67], v[104:105]
    v_pk_fma_f32 v[108:109], v[108:109], v[82:83], v[108:109]
    v_pk_fma_f32 v[102:103], v[32:33], v[66:67], v[110:111]
    v_pk_fma_f32 v[106:107], v[48:49], v[82:83], v[112:113]
    v_pk_fma_f32 v[110:111], v[36:37], v[104:105], v[102:103]
    v_pk_fma_f32 v[112:113], v[52:53], v[108:109], v[106:107]
    v_pk_fma_f32 v[104:105], v[104:105], v[68:69], v[104:105]
    v_pk_fma_f32 v[108:109], v[108:109], v[84:85], v[108:109]
    v_pk_fma_f32 v[102:103], v[102:103], v[68:69], v[110:111]
    v_pk_fma_f32 v[106:107], v[106:107], v[84:85], v[112:113]
    v_pk_fma_f32 v[110:111], v[38:39], v[104:105], v[102:103]
    v_pk_fma_f32 v[112:113], v[54:55], v[108:109], v[106:107]
    v_pk_fma_f32 v[104:105], v[104:105], v[70:71], v[104:105]
    v_pk_fma_f32 v[108:109], v[108:109], v[86:87], v[108:109]
    v_pk_fma_f32 v[102:103], v[102:103], v[70:71], v[110:111]
    v_pk_fma_f32 v[106:107], v[106:107], v[86:87], v[112:113]
    s_cbranch_vccnz K_va10
    s_waitcnt vmcnt(0)
    ds_read_b32 v96, v142 offset:128
    ds_read_b32 v97, v142 offset:14208
    ds_read_b32 v98, v143 offset:0
    ds_read_b32 v100, v143 offset:256
    ds_read_b64_tr_b16 v[0:1], v140 offset:0
    ds_read_b64_tr_b16 v[16:17], v140 offset:128
    ds_read_b64_tr_b16 v[2:3], v140 offset:512
    ds_read_b64_tr_b16 v[18:19], v140 offset:640
    ds_read_b64_tr_b16 v[4:5], v140 offset:1024
    ds_read_b64_tr_b16 v[20:21], v140 offset:1152
    ds_read_b64_tr_b16 v[6:7], v140 offset:1536
    ds_read_b64_tr_b16 v[22:23], v140 offset:1664
    ds_read_b64_tr_b16 v[8:9], v140 offset:2048
    ds_read_b64_tr_b16 v[24:25], v140 offset:2176
    ds_read_b64_tr_b16 v[10:11], v140 offset:2560
    ds_read_b64_tr_b16 v[26:27], v140 offset:2688
    ds_read_b64_tr_b16 v[12:13], v140 offset:3072
    ds_read_b64_tr_b16 v[28:29], v140 offset:3200
    ds_read_b64_tr_b16 v[14:15], v140 offset:3584
    ds_read_b64_tr_b16 v[30:31], v140 offset:3712
    ds_read_u16 v132, v141 offset:96
    ds_read_u16 v134, v141 offset:104
    ds_read_u16 v136, v141 offset:112
    ds_read_u16 v138, v141 offset:120
.p2align 3
K_va10:
.p2align 3
    v_pk_fma_f32 v[110:111], v[40:41], v[104:105], v[102:103]
    v_pk_fma_f32 v[112:113], v[56:57], v[108:109], v[106:107]
    v_pk_fma_f32 v[104:105], v[104:105], v[72:73], v[104:105]
    v_pk_fma_f32 v[108:109], v[108:109], v[88:89], v[108:109]
    v_pk_fma_f32 v[102:103], v[102:103], v[72:73], v[110:111]
    v_pk_fma_f32 v[106:107], v[106:107], v[88:89], v[112:113]
    v_pk_fma_f32 v[110:111], v[42:43], v[104:105], v[102:103]
    v_pk_fma_f32 v[112:113], v[58:59], v[108:109], v[106:107]
    v_pk_fma_f32 v[104:105], v[104:105], v[74:75], v[104:105]
    v_pk_fma_f32 v[108:109], v[108:109], v[90:91], v[108:109]
    v_pk_fma_f32 v[102:103], v[102:103], v[74:75], v[110:111]
    v_pk_fma_f32 v[106:107], v[106:107], v[90:91], v[112:113]
    s_cbranch_vccnz K_vb10
    s_waitcnt lgkmcnt(0)
    buffer_load_dwordx4 v[132:133], s[36:39], s48 idxen offen offset:0 sc1 lds
    buffer_load_dwordx4 v[134:135], s[36:39], s49 idxen offen offset:1024 sc1 lds
    buffer_load_dwordx4 v[136:137], s[36:39], s50 idxen offen offset:2048 sc1 lds
    buffer_load_dwordx4 v[138:139], s[36:39], s51 idxen offen offset:3072 sc1 lds
    v_mfma_f32_32x32x8_bf16 v[0:15], v[96:97], v[98:99], v[0:15]
K_vb10:
    v_exp_f32 v76, v44
    v_exp_f32 v77, v45
    v_exp_f32 v92, v60
    v_exp_f32 v93, v61
    v_mfma_f32_32x32x8_bf16 v[16:31], v[96:97], v[100:101], v[16:31]
    v_exp_f32 v78, v46
    v_exp_f32 v79, v47
    v_exp_f32 v94, v62
    v_exp_f32 v95, v63
    v_add_u32 v142, v144, v142
    v_add_u32 v141, 64, v141
    v_add_u32 v143, 0x200, v143
    s_lshr_b32 s34, s52, 16
    s_add_u32 s34, s34, s32
    s_addc_u32 s35, s33, 0
.p2align 3
    v_pk_fma_f32 v[110:111], v[44:45], v[104:105], v[102:103]
    v_pk_fma_f32 v[112:113], v[60:61], v[108:109], v[106:107]
    v_pk_fma_f32 v[104:105], v[104:105], v[76:77], v[104:105]
    v_pk_fma_f32 v[108:109], v[108:109], v[92:93], v[108:109]
    v_pk_fma_f32 v[102:103], v[102:103], v[76:77], v[110:111]
    v_pk_fma_f32 v[106:107], v[106:107], v[92:93], v[112:113]
    v_pk_fma_f32 v[110:111], v[46:47], v[104:105], v[102:103]
    v_pk_fma_f32 v[112:113], v[62:63], v[108:109], v[106:107]
    v_pk_fma_f32 v[104:105], v[104:105], v[78:79], v[104:105]
    v_pk_fma_f32 v[108:109], v[108:109], v[94:95], v[108:109]
    v_pk_fma_f32 v[102:103], v[102:103], v[78:79], v[110:111]
    v_pk_fma_f32 v[106:107], v[106:107], v[94:95], v[112:113]
    v_add_u32 v145, 288, v145
    s_setpc_b64 s[34:35]
.org K_vbase + 10560, 0
    s_setprio 2
    s_branch K_var11
    s_setprio 1
    s_branch K_var11
    s_mov_b64 vcc, -1
    s_branch K_var11
    s_setprio 0
    s_mov_b32 s38, 0
K_var11:
    v_exp_f32 v64, v32
    v_exp_f32 v65, v33
    v_exp_f32 v80, v48
    v_exp_f32 v81, v49
    v_exp_f32 v66, v34
    v_exp_f32 v67, v35
    v_exp_f32 v82, v50
    v_exp_f32 v83, v51
    v_exp_f32 v68, v36
    v_exp_f32 v69, v37
    v_exp_f32 v84, v52
    v_exp_f32 v85, v53
    v_exp_f32 v70, v38
    v_exp_f32 v71, v39
    v_exp_f32 v86, v54
    v_exp_f32 v87, v55
    v_exp_f32 v72, v40
    v_exp_f32 v73, v41
    v_exp_f32 v88, v56
    v_exp_f32 v89, v57
    v_exp_f32 v74, v42
    v_exp_f32 v75, v43
    v_exp_f32 v90, v58
    v_exp_f32 v91, v59
.p2align 3
    v_pk_fma_f32 v[110:111], v[32:33], v[104:105], v[102:103]
    v_pk_fma_f32 v[112:113], v[48:49], v[108:109], v[106:107]
    v_pk_fma_f32 v[104:105], v[104:105], v[64:65], v[104:105]
    v_pk_fma_f32 v[108:109], v[108:109], v[80:81], v[108:109]
    v_pk_fma_f32 v[102:103], v[102:103], v[64:65], v[110:111]
    v_pk_fma_f32 v[106:107], v[106:107], v[80:81], v[112:113]
    v_rcp_f32 v114, v104
    v_rcp_f32 v115, v105
    v_rcp_f32 v116, v108
    v_rcp_f32 v117, v109
    v_pk_add_f32 v[104:105], v[66:67], 1.0 op_sel_hi:[1,0]
    v_pk_add_f32 v[108:109], v[82:83], 1.0 op_sel_hi:[1,0]
    v_pk_mul_f32 v[118:119], v[102:103], v[114:115]
    v_pk_mul_f32 v[120:121], v[106:107], v[116:117]
    v_min3_f32 v146, v146, v114, v115
    v_min3_f32 v146, v146, v116, v117
    v_add_f32 v118, v118, v119
    v_add_f32 v120, v120, v121
    v_cvt_pk_bf16_f32 v118, v118, v120
    ds_write_b32 v145, v118
    v_pk_fma_f32 v[110:111], v[36:37], v[104:105], v[34:35]
    v_pk_fma_f32 v[112:113], v[52:53], v[108:109], v[50:51]
    v_pk_fma_f32 v[104:105], v[104:105], v[68:69], v[104:105]
    v_pk_fma_f32 v[108:109], v[108:109], v[84:85], v[108:109]
    v_pk_fma_f32 v[102:103], v[34:35], v[68:69], v[110:111]
    v_pk_fma_f32 v[106:107], v[50:51], v[84:85], v[112:113]
    v_pk_fma_f32 v[110:111], v[38:39], v[104:105], v[102:103]
    v_pk_fma_f32 v[112:113], v[54:55], v[108:109], v[106:107]
    v_pk_fma_f32 v[104:105], v[104:105], v[70:71], v[104:105]
    v_pk_fma_f32 v[108:109], v[108:109], v[86:87], v[108:109]
    v_pk_fma_f32 v[102:103], v[102:103], v[70:71], v[110:111]
    v_pk_fma_f32 v[106:107], v[106:107], v[86:87], v[112:113]
    s_cbranch_vccnz K_va11
    s_waitcnt vmcnt(0)
    ds_read_b32 v96, v142 offset:128
    ds_read_b32 v97, v142 offset:14208
    ds_read_b32 v98, v143 offset:0
    ds_read_b32 v100, v143 offset:256
    ds_read_b64_tr_b16 v[0:1], v140 offset:0
    ds_read_b64_tr_b16 v[16:17], v140 offset:128
    ds_read_b64_tr_b16 v[2:3], v140 offset:512
    ds_read_b64_tr_b16 v[18:19], v140 offset:640
    ds_read_b64_tr_b16 v[4:5], v140 offset:1024
    ds_read_b64_tr_b16 v[20:21], v140 offset:1152
    ds_read_b64_tr_b16 v[6:7], v140 offset:1536
    ds_read_b64_tr_b16 v[22:23], v140 offset:1664
    ds_read_b64_tr_b16 v[8:9], v140 offset:2048
    ds_read_b64_tr_b16 v[24:25], v140 offset:2176
    ds_read_b64_tr_b16 v[10:11], v140 offset:2560
    ds_read_b64_tr_b16 v[26:27], v140 offset:2688
    ds_read_b64_tr_b16 v[12:13], v140 offset:3072
    ds_read_b64_tr_b16 v[28:29], v140 offset:3200
    ds_read_b64_tr_b16 v[14:15], v140 offset:3584
    ds_read_b64_tr_b16 v[30:31], v140 offset:3712
    ds_read_u16 v132, v141 offset:96
    ds_read_u16 v134, v141 offset:104
    ds_read_u16 v136, v141 offset:112
    ds_read_u16 v138, v141 offset:120
.p2align 3
K_va11:
.p2align 3
    v_pk_fma_f32 v[110:111], v[40:41], v[104:105], v[102:103]
    v_pk_fma_f32 v[112:113], v[56:57], v[108:109], v[106:107]
    v_pk_fma_f32 v[104:105], v[104:105], v[72:73], v[104:105]
    v_pk_fma_f32 v[108:109], v[108:109], v[88:89], v[108:109]
    v_pk_fma_f32 v[102:103], v[102:103], v[72:73], v[110:111]
    v_pk_fma_f32 v[106:107], v[106:107], v[88:89], v[112:113]
    v_pk_fma_f32 v[110:111], v[42:43], v[104:105], v[102:103]
    v_pk_fma_f32 v[112:113], v[58:59], v[108:109], v[106:107]
    v_pk_fma_f32 v[104:105], v[104:105], v[74:75], v[104:105]
    v_pk_fma_f32 v[108:109], v[108:109], v[90:91], v[108:109]
    v_pk_fma_f32 v[102:103], v[102:103], v[74:75], v[110:111]
    v_pk_fma_f32 v[106:107], v[106:107], v[90:91], v[112:113]
    s_cbranch_vccnz K_vb11
    s_waitcnt lgkmcnt(0)
    buffer_load_dwordx4 v[132:133], s[36:39], s48 idxen offen offset:0 sc1 lds
    buffer_load_dwordx4 v[134:135], s[36:39], s49 idxen offen offset:1024 sc1 lds
    buffer_load_dwordx4 v[136:137], s[36:39], s50 idxen offen offset:2048 sc1 lds
    buffer_load_dwordx4 v[138:139], s[36:39], s51 idxen offen offset:3072 sc1 lds
    v_mfma_f32_32x32x8_bf16 v[0:15], v[96:97], v[98:99], v[0:15]
K_vb11:
    v_exp_f32 v76, v44
    v_exp_f32 v77, v45
    v_exp_f32 v92, v60
    v_exp_f32 v93, v61
    v_mfma_f32_32x32x8_bf16 v[16:31], v[96:97], v[100:101], v[16:31]
    v_exp_f32 v78, v46
    v_exp_f32 v79, v47
    v_exp_f32 v94, v62
    v_exp_f32 v95, v63
    v_add_u32 v142, v144, v142
    v_add_u32 v141, 64, v141
    v_add_u32 v143, 0x200, v143
    s_lshr_b32 s34, s52, 16
    s_add_u32 s34, s34, s32
    s_addc_u32 s35, s33, 0
.p2align 3
    v_pk_fma_f32 v[110:111], v[44:45], v[104:105], v[102:103]
    v_pk_fma_f32 v[112:113], v[60:61], v[108:109], v[106:107]
    v_pk_fma_f32 v[104:105], v[104:105], v[76:77], v[104:105]
    v_pk_fma_f32 v[108:109], v[108:109], v[92:93], v[108:109]
    v_pk_fma_f32 v[102:103], v[102:103], v[76:77], v[110:111]
    v_pk_fma_f32 v[106:107], v[106:107], v[92:93], v[112:113]
    v_pk_fma_f32 v[110:111], v[46:47], v[104:105], v[102:103]
    v_pk_fma_f32 v[112:113], v[62:63], v[108:109], v[106:107]
    v_pk_fma_f32 v[104:105], v[104:105], v[78:79], v[104:105]
    v_pk_fma_f32 v[108:109], v[108:109], v[94:95], v[108:109]
    v_pk_fma_f32 v[102:103], v[102:103], v[78:79], v[110:111]
    v_pk_fma_f32 v[106:107], v[106:107], v[94:95], v[112:113]
    v_add_u32 v145, 288, v145
    s_setpc_b64 s[34:35]
.org K_vbase + 11520, 0
    s_setprio 2
    s_branch K_var12
    s_setprio 1
    s_branch K_var12
    s_mov_b64 vcc, -1
    s_branch K_var12
    s_setprio 0
    s_mov_b32 s38, 0
K_var12:
    v_exp_f32 v64, v32
    v_exp_f32 v65, v33
    v_exp_f32 v80, v48
    v_exp_f32 v81, v49
    v_exp_f32 v66, v34
    v_exp_f32 v67, v35
    v_exp_f32 v82, v50
    v_exp_f32 v83, v51
    v_exp_f32 v68, v36
    v_exp_f32 v69, v37
    v_exp_f32 v84, v52
    v_exp_f32 v85, v53
    v_exp_f32 v70, v38
    v_exp_f32 v71, v39
    v_exp_f32 v86, v54
    v_exp_f32 v87, v55
    v_exp_f32 v72, v40
    v_exp_f32 v73, v41
    v_exp_f32 v88, v56
    v_exp_f32 v89, v57
    v_exp_f32 v74, v42
    v_exp_f32 v75, v43
    v_exp_f32 v90, v58
    v_exp_f32 v91, v59
.p2align 3
    v_pk_fma_f32 v[110:111], v[32:33], v[104:105], v[102:103]
    v_pk_fma_f32 v[112:113], v[48:49], v[108:109], v[106:107]
    v_pk_fma_f32 v[104:105], v[104:105], v[64:65], v[104:105]
    v_pk_fma_f32 v[108:109], v[108:109], v[80:81], v[108:109]
    v_pk_fma_f32 v[102:103], v[102:103], v[64:65], v[110:111]
    v_pk_fma_f32 v[106:107], v[106:107], v[80:81], v[112:113]
    v_pk_fma_f32 v[110:111], v[34:35], v[104:105], v[102:103]
    v_pk_fma_f32 v[112:113], v[50:51], v[108:109], v[106:107]
    v_pk_fma_f32 v[104:105], v[104:105], v[66:67], v[104:105]
    v_pk_fma_f32 v[108:109], v[108:109], v[82:83], v[108:109]
    v_pk_fma_f32 v[102:103], v[102:103], v[66:67], v[110:111]
    v_pk_fma_f32 v[106:107], v[106:107], v[82:83], v[112:113]
    v_rcp_f32 v114, v104
    v_rcp_f32 v115, v105
    v_rcp_f32 v116, v108
    v_rcp_f32 v117, v109
    v_pk_add_f32 v[104:105], v[68:69], 1.0 op_sel_hi:[1,0]
    v_pk_add_f32 v[108:109], v[84:85], 1.0 op_sel_hi:[1,0]
    v_pk_mul_f32 v[118:119], v[102:103], v[114:115]
    v_pk_mul_f32 v[120:121], v[106:107], v[116:117]
    v_min3_f32 v146, v146, v114, v115
    v_min3_f32 v146, v146, v116, v117
    v_add_f32 v118, v118, v119
    v_add_f32 v120, v120, v121
    v_cvt_pk_bf16_f32 v118, v118, v120
    ds_write_b32 v145, v118
    v_pk_fma_f32 v[110:111], v[38:39], v[104:105], v[36:37]
    v_pk_fma_f32 v[112:113], v[54:55], v[108:109], v[52:53]
    v_pk_fma_f32 v[104:105], v[104:105], v[70:71], v[104:105]
    v_pk_fma_f32 v[108:109], v[108:109], v[86:87], v[108:109]
    v_pk_fma_f32 v[102:103], v[36:37], v[70:71], v[110:111]
    v_pk_fma_f32 v[106:107], v[52:53], v[86:87], v[112:113]
    s_cbranch_vccnz K_va12
    s_waitcnt vmcnt(0)
    ds_read_b32 v96, v142 offset:128
    ds_read_b32 v97, v142 offset:14208
    ds_read_b32 v98, v143 offset:0
    ds_read_b32 v100, v143 offset:256
    ds_read_b64_tr_b16 v[0:1], v140 offset:0
    ds_read_b64_tr_b16 v[16:17], v140 offset:128
    ds_read_b64_tr_b16 v[2:3], v140 offset:512
    ds_read_b64_tr_b16 v[18:19], v140 offset:640
    ds_read_b64_tr_b16 v[4:5], v140 offset:1024
    ds_read_b64_tr_b16 v[20:21], v140 offset:1152
    ds_read_b64_tr_b16 v[6:7], v140 offset:1536
    ds_read_b64_tr_b16 v[22:23], v140 offset:1664
    ds_read_b64_tr_b16 v[8:9], v140 offset:2048
    ds_read_b64_tr_b16 v[24:25], v140 offset:2176
    ds_read_b64_tr_b16 v[10:11], v140 offset:2560
    ds_read_b64_tr_b16 v[26:27], v140 offset:2688
    ds_read_b64_tr_b16 v[12:13], v140 offset:3072
    ds_read_b64_tr_b16 v[28:29], v140 offset:3200
    ds_read_b64_tr_b16 v[14:15], v140 offset:3584
    ds_read_b64_tr_b16 v[30:31], v140 offset:3712
    ds_read_u16 v132, v141 offset:96
    ds_read_u16 v134, v141 offset:104
    ds_read_u16 v136, v141 offset:112
    ds_read_u16 v138, v141 offset:120
.p2align 3
K_va12:
.p2align 3
    v_pk_fma_f32 v[110:111], v[40:41], v[104:105], v[102:103]
    v_pk_fma_f32 v[112:113], v[56:57], v[108:109], v[106:107]
    v_pk_fma_f32 v[104:105], v[104:105], v[72:73], v[104:105]
    v_pk_fma_f32 v[108:109], v[108:109], v[88:89], v[108:109]
    v_pk_fma_f32 v[102:103], v[102:103], v[72:73], v[110:111]
    v_pk_fma_f32 v[106:107], v[106:107], v[88:89], v[112:113]
    v_pk_fma_f32 v[110:111], v[42:43], v[104:105], v[102:103]
    v_pk_fma_f32 v[112:113], v[58:59], v[108:109], v[106:107]
    v_pk_fma_f32 v[104:105], v[104:105], v[74:75], v[104:105]
    v_pk_fma_f32 v[108:109], v[108:109], v[90:91], v[108:109]
    v_pk_fma_f32 v[102:103], v[102:103], v[74:75], v[110:111]
    v_pk_fma_f32 v[106:107], v[106:107], v[90:91], v[112:113]
    s_cbranch_vccnz K_vb12
    s_waitcnt lgkmcnt(0)
    buffer_load_dwordx4 v[132:133], s[36:39], s48 idxen offen offset:0 sc1 lds
    buffer_load_dwordx4 v[134:135], s[36:39], s49 idxen offen offset:1024 sc1 lds
    buffer_load_dwordx4 v[136:137], s[36:39], s50 idxen offen offset:2048 sc1 lds
    buffer_load_dwordx4 v[138:139], s[36:39], s51 idxen offen offset:3072 sc1 lds
    v_mfma_f32_32x32x8_bf16 v[0:15], v[96:97], v[98:99], v[0:15]
K_vb12:
    v_exp_f32 v76, v44
    v_exp_f32 v77, v45
    v_exp_f32 v92, v60
    v_exp_f32 v93, v61
    v_mfma_f32_32x32x8_bf16 v[16:31], v[96:97], v[100:101], v[16:31]
    v_exp_f32 v78, v46
    v_exp_f32 v79, v47
    v_exp_f32 v94, v62
    v_exp_f32 v95, v63
    v_add_u32 v142, v144, v142
    v_add_u32 v141, 64, v141
    v_add_u32 v143, 0x200, v143
    s_lshr_b32 s34, s52, 16
    s_add_u32 s34, s34, s32
    s_addc_u32 s35, s33, 0
.p2align 3
    v_pk_fma_f32 v[110:111], v[44:45], v[104:105], v[102:103]
    v_pk_fma_f32 v[112:113], v[60:61], v[108:109], v[106:107]
    v_pk_fma_f32 v[104:105], v[104:105], v[76:77], v[104:105]
    v_pk_fma_f32 v[108:109], v[108:109], v[92:93], v[108:109]
    v_pk_fma_f32 v[102:103], v[102:103], v[76:77], v[110:111]
    v_pk_fma_f32 v[106:107], v[106:107], v[92:93], v[112:113]
    v_pk_fma_f32 v[110:111], v[46:47], v[104:105], v[102:103]
    v_pk_fma_f32 v[112:113], v[62:63], v[108:109], v[106:107]
    v_pk_fma_f32 v[104:105], v[104:105], v[78:79], v[104:105]
    v_pk_fma_f32 v[108:109], v[108:109], v[94:95], v[108:109]
    v_pk_fma_f32 v[102:103], v[102:103], v[78:79], v[110:111]
    v_pk_fma_f32 v[106:107], v[106:107], v[94:95], v[112:113]
    v_add_u32 v145, 288, v145
    s_setpc_b64 s[34:35]
.org K_vbase + 12480, 0
    s_setprio 2
    s_branch K_var13
    s_setprio 1
    s_branch K_var13
    s_mov_b64 vcc, -1
    s_branch K_var13
    s_setprio 0
    s_mov_b32 s38, 0
K_var13:
    v_exp_f32 v64, v32
    v_exp_f32 v65, v33
    v_exp_f32 v80, v48
    v_exp_f32 v81, v49
    v_exp_f32 v66, v34
    v_exp_f32 v67, v35
    v_exp_f32 v82, v50
    v_exp_f32 v83, v51
    v_exp_f32 v68, v36
    v_exp_f32 v69, v37
    v_exp_f32 v84, v52
    v_exp_f32 v85, v53
    v_exp_f32 v70, v38
    v_exp_f32 v71, v39
    v_exp_f32 v86, v54
    v_exp_f32 v87, v55
    v_exp_f32 v72, v40
    v_exp_f32 v73, v41
    v_exp_f32 v88, v56
    v_exp_f32 v89, v57
    v_exp_f32 v74, v42
    v_exp_f32 v75, v43
    v_exp_f32 v90, v58
    v_exp_f32 v91, v59
.p2align 3
    v_pk_fma_f32 v[110:111], v[32:33], v[104:105], v[102:103]
    v_pk_fma_f32 v[112:113], v[48:49], v[108:109], v[106:107]
    v_pk_fma_f32 v[104:105], v[104:105], v[64:65], v[104:105]
    v_pk_fma_f32 v[108:109], v[108:109], v[80:81], v[108:109]
    v_pk_fma_f32 v[102:103], v[102:103], v[64:65], v[110:111]
    v_pk_fma_f32 v[106:107], v[106:107], v[80:81], v[112:113]
    v_pk_fma_f32 v[110:111], v[34:35], v[104:105], v[102:103]
    v_pk_fma_f32 v[112:113], v[50:51], v[108:109], v[106:107]
    v_pk_fma_f32 v[104:105], v[104:105], v[66:67], v[104:105]
    v_pk_fma_f32 v[108:109], v[108:109], v[82:83], v[108:109]
    v_pk_fma_f32 v[102:103], v[102:103], v[66:67], v[110:111]
    v_pk_fma_f32 v[106:107], v[106:107], v[82:83], v[112:113]
    v_pk_fma_f32 v[110:111], v[36:37], v[104:105], v[102:103]
    v_pk_fma_f32 v[112:113], v[52:53], v[108:109], v[106:107]
    v_pk_fma_f32 v[104:105], v[104:105], v[68:69], v[104:105]
    v_pk_fma_f32 v[108:109], v[108:109], v[84:85], v[108:109]
    v_pk_fma_f32 v[102:103], v[102:103], v[68:69], v[110:111]
    v_pk_fma_f32 v[106:107], v[106:107], v[84:85], v[112:113]
    v_rcp_f32 v114, v104
    v_rcp_f32 v115, v105
    v_rcp_f32 v116, v108
    v_rcp_f32 v117, v109
    v_pk_add_f32 v[104:105], v[70:71], 1.0 op_sel_hi:[1,0]
    v_pk_add_f32 v[108:109], v[86:87], 1.0 op_sel_hi:[1,0]
    v_pk_mul_f32 v[118:119], v[102:103], v[114:115]
    v_pk_mul_f32 v[120:121], v[106:107], v[116:117]
    v_min3_f32 v146, v146, v114, v115
    v_min3_f32 v146, v146, v116, v117
    v_add_f32 v118, v118, v119
    v_add_f32 v120, v120, v121
    v_cvt_pk_bf16_f32 v118, v118, v120
    ds_write_b32 v145, v118
    s_cbranch_vccnz K_va13
    s_waitcnt vmcnt(0)
    ds_read_b32 v96, v142 offset:128
    ds_read_b32 v97, v142 offset:14208
    ds_read_b32 v98, v143 offset:0
    ds_read_b32 v100, v143 offset:256
    ds_read_b64_tr_b16 v[0:1], v140 offset:0
    ds_read_b64_tr_b16 v[16:17], v140 offset:128
    ds_read_b64_tr_b16 v[2:3], v140 offset:512
    ds_read_b64_tr_b16 v[18:19], v140 offset:640
    ds_read_b64_tr_b16 v[4:5], v140 offset:1024
    ds_read_b64_tr_b16 v[20:21], v140 offset:1152
    ds_read_b64_tr_b16 v[6:7], v140 offset:1536
    ds_read_b64_tr_b16 v[22:23], v140 offset:1664
    ds_read_b64_tr_b16 v[8:9], v140 offset:2048
    ds_read_b64_tr_b16 v[24:25], v140 offset:2176
    ds_read_b64_tr_b16 v[10:11], v140 offset:2560
    ds_read_b64_tr_b16 v[26:27], v140 offset:2688
    ds_read_b64_tr_b16 v[12:13], v140 offset:3072
    ds_read_b64_tr_b16 v[28:29], v140 offset:3200
    ds_read_b64_tr_b16 v[14:15], v140 offset:3584
    ds_read_b64_tr_b16 v[30:31], v140 offset:3712
    ds_read_u16 v132, v141 offset:96
    ds_read_u16 v134, v141 offset:104
    ds_read_u16 v136, v141 offset:112
    ds_read_u16 v138, v141 offset:120
.p2align 3
K_va13:
.p2align 3
    v_pk_fma_f32 v[110:111], v[40:41], v[104:105], v[38:39]
    v_pk_fma_f32 v[112:113], v[56:57], v[108:109], v[54:55]
    v_pk_fma_f32 v[104:105], v[104:105], v[72:73], v[104:105]
    v_pk_fma_f32 v[108:109], v[108:109], v[88:89], v[108:109]
    v_pk_fma_f32 v[102:103], v[38:39], v[72:73], v[110:111]
    v_pk_fma_f32 v[106:107], v[54:55], v[88:89], v[112:113]
    v_pk_fma_f32 v[110:111], v[42:43], v[104:105], v[102:103]
    v_pk_fma_f32 v[112:113], v[58:59], v[108:109], v[106:107]
    v_pk_fma_f32 v[104:105], v[104:105], v[74:75], v[104:105]
    v_pk_fma_f32 v[108:109], v[108:109], v[90:91], v[108:109]
    v_pk_fma_f32 v[102:103], v[102:103], v[74:75], v[110:111]
    v_pk_fma_f32 v[106:107], v[106:107], v[90:91], v[112:113]
    s_cbranch_vccnz K_vb13
    s_waitcnt lgkmcnt(0)
    buffer_load_dwordx4 v[132:133], s[36:39], s48 idxen offen offset:0 sc1 lds
    buffer_load_dwordx4 v[134:135], s[36:39], s49 idxen offen offset:1024 sc1 lds
    buffer_load_dwordx4 v[136:137], s[36:39], s50 idxen offen offset:2048 sc1 lds
    buffer_load_dwordx4 v[138:139], s[36:39], s51 idxen offen offset:3072 sc1 lds
    v_mfma_f32_32x32x8_bf16 v[0:15], v[96:97], v[98:99], v[0:15]
K_vb13:
    v_exp_f32 v76, v44
    v_exp_f32 v77, v45
    v_exp_f32 v92, v60
    v_exp_f32 v93, v61
    v_mfma_f32_32x32x8_bf16 v[16:31], v[96:97], v[100:101], v[16:31]
    v_exp_f32 v78, v46
    v_exp_f32 v79, v47
    v_exp_f32 v94, v62
    v_exp_f32 v95, v63
    v_add_u32 v142, v144, v142
    v_add_u32 v141, 64, v141
    v_add_u32 v143, 0x200, v143
    s_lshr_b32 s34, s52, 16
    s_add_u32 s34, s34, s32
    s_addc_u32 s35, s33, 0
.p2align 3
    v_pk_fma_f32 v[110:111], v[44:45], v[104:105], v[102:103]
    v_pk_fma_f32 v[112:113], v[60:61], v[108:109], v[106:107]
    v_pk_fma_f32 v[104:105], v[104:105], v[76:77], v[104:105]
    v_pk_fma_f32 v[108:109], v[108:109], v[92:93], v[108:109]
    v_pk_fma_f32 v[102:103], v[102:103], v[76:77], v[110:111]
    v_pk_fma_f32 v[106:107], v[106:107], v[92:93], v[112:113]
    v_pk_fma_f32 v[110:111], v[46:47], v[104:105], v[102:103]
    v_pk_fma_f32 v[112:113], v[62:63], v[108:109], v[106:107]
    v_pk_fma_f32 v[104:105], v[104:105], v[78:79], v[104:105]
    v_pk_fma_f32 v[108:109], v[108:109], v[94:95], v[108:109]
    v_pk_fma_f32 v[102:103], v[102:103], v[78:79], v[110:111]
    v_pk_fma_f32 v[106:107], v[106:107], v[94:95], v[112:113]
    v_add_u32 v145, 288, v145
    s_setpc_b64 s[34:35]
.org K_vbase + 13440, 0
    s_setprio 2
    s_branch K_var14
    s_setprio 1
    s_branch K_var14
    s_mov_b64 vcc, -1
    s_branch K_var14
    s_setprio 0
    s_mov_b32 s38, 0
K_var14:
    v_exp_f32 v64, v32
    v_exp_f32 v65, v33
    v_exp_f32 v80, v48
    v_exp_f32 v81, v49
    v_exp_f32 v66, v34
    v_exp_f32 v67, v35
    v_exp_f32 v82, v50
    v_exp_f32 v83, v51
    v_exp_f32 v68, v36
    v_exp_f32 v69, v37
    v_exp_f32 v84, v52
    v_exp_f32 v85, v53
    v_exp_f32 v70, v38
    v_exp_f32 v71, v39
    v_exp_f32 v86, v54
    v_exp_f32 v87, v55
    v_exp_f32 v72, v40
    v_exp_f32 v73, v41
    v_exp_f32 v88, v56
    v_exp_f32 v89, v57
    v_exp_f32 v74, v42
    v_exp_f32 v75, v43
    v_exp_f32 v90, v58
    v_exp_f32 v91, v59
.p2align 3
    v_pk_fma_f32 v[110:111], v[32:33], v[104:105], v[102:103]
    v_pk_fma_f32 v[112:113], v[48:49], v[108:109], v[106:107]
    v_pk_fma_f32 v[104:105], v[104:105], v[64:65], v[104:105]
    v_pk_fma_f32 v[108:109], v[108:109], v[80:81], v[108:109]
    v_pk_fma_f32 v[102:103], v[102:103], v[64:65], v[110:111]
    v_pk_fma_f32 v[106:107], v[106:107], v[80:81], v[112:113]
    v_pk_fma_f32 v[110:111], v[34:35], v[104:105], v[102:103]
    v_pk_fma_f32 v[112:113], v[50:51], v[108:109], v[106:107]
    v_pk_fma_f32 v[104:105], v[104:105], v[66:67], v[104:105]
    v_pk_fma_f32 v[108:109], v[108:109], v[82:83], v[108:109]
    v_pk_fma_f32 v[102:103], v[102:103], v[66:67], v[110:111]
    v_pk_fma_f32 v[106:107], v[106:107], v[82:83], v[112:113]
    v_pk_fma_f32 v[110:111], v[36:37], v[104:105], v[102:103]
    v_pk_fma_f32 v[112:113], v[52:53], v[108:109], v[106:107]
    v_pk_fma_f32 v[104:105], v[104:105], v[68:69], v[104:105]
    v_pk_fma_f32 v[108:109], v[108:109], v[84:85], v[108:109]
    v_pk_fma_f32 v[102:103], v[102:103], v[68:69], v[110:111]
    v_pk_fma_f32 v[106:107], v[106:107], v[84:85], v[112:113]
    v_pk_fma_f32 v[110:111], v[38:39], v[104:105], v[102:103]
    v_pk_fma_f32 v[112:113], v[54:55], v[108:109], v[106:107]
    v_pk_fma_f32 v[104:105], v[104:105], v[70:71], v[104:105]
    v_pk_fma_f32 v[108:109], v[108:109], v[86:87], v[108:109]
    v_pk_fma_f32 v[102:103], v[102:103], v[70:71], v[110:111]
    v_pk_fma_f32 v[106:107], v[106:107], v[86:87], v[112:113]
    s_cbranch_vccnz K_va14
    s_waitcnt vmcnt(0)
    ds_read_b32 v96, v142 offset:128
    ds_read_b32 v97, v142 offset:14208
    ds_read_b32 v98, v143 offset:0
    ds_read_b32 v100, v143 offset:256
    ds_read_b64_tr_b16 v[0:1], v140 offset:0
    ds_read_b64_tr_b16 v[16:17], v140 offset:128
    ds_read_b64_tr_b16 v[2:3], v140 offset:512
    ds_read_b64_tr_b16 v[18:19], v140 offset:640
    ds_read_b64_tr_b16 v[4:5], v140 offset:1024
    ds_read_b64_tr_b16 v[20:21], v140 offset:1152
    ds_read_b64_tr_b16 v[6:7], v140 offset:1536
    ds_read_b64_tr_b16 v[22:23], v140 offset:1664
    ds_read_b64_tr_b16 v[8:9], v140 offset:2048
    ds_read_b64_tr_b16 v[24:25], v140 offset:2176
    ds_read_b64_tr_b16 v[10:11], v140 offset:2560
    ds_read_b64_tr_b16 v[26:27], v140 offset:2688
    ds_read_b64_tr_b16 v[12:13], v140 offset:3072
    ds_read_b64_tr_b16 v[28:29], v140 offset:3200
    ds_read_b64_tr_b16 v[14:15], v140 offset:3584
    ds_read_b64_tr_b16 v[30:31], v140 offset:3712
    ds_read_u16 v132, v141 offset:96
    ds_read_u16 v134, v141 offset:104
    ds_read_u16 v136, v141 offset:112
    ds_read_u16 v138, v141 offset:120
.p2align 3
K_va14:
.p2align 3
    v_rcp_f32 v114, v104
    v_rcp_f32 v115, v105
    v_rcp_f32 v116, v108
    v_rcp_f32 v117, v109
    v_pk_add_f32 v[104:105], v[72:73], 1.0 op_sel_hi:[1,0]
    v_pk_add_f32 v[108:109], v[88:89], 1.0 op_sel_hi:[1,0]
    v_pk_mul_f32 v[118:119], v[102:103], v[114:115]
    v_pk_mul_f32 v[120:121], v[106:107], v[116:117]
    v_min3_f32 v146, v146, v114, v115
    v_min3_f32 v146, v146, v116, v117
    v_add_f32 v118, v118, v119
    v_add_f32 v120, v120, v121
    v_cvt_pk_bf16_f32 v118, v118, v120
    ds_write_b32 v145, v118
    v_pk_fma_f32 v[110:111], v[42:43], v[104:105], v[40:41]
    v_pk_fma_f32 v[112:113], v[58:59], v[108:109], v[56:57]
    v_pk_fma_f32 v[104:105], v[104:105], v[74:75], v[104:105]
    v_pk_fma_f32 v[108:109], v[108:109], v[90:91], v[108:109]
    v_pk_fma_f32 v[102:103], v[40:41], v[74:75], v[110:111]
    v_pk_fma_f32 v[106:107], v[56:57], v[90:91], v[112:113]
    s_cbranch_vccnz K_vb14
    s_waitcnt lgkmcnt(0)
    buffer_load_dwordx4 v[132:133], s[36:39], s48 idxen offen offset:0 sc1 lds
    buffer_load_dwordx4 v[134:135], s[36:39], s49 idxen offen offset:1024 sc1 lds
    buffer_load_dwordx4 v[136:137], s[36:39], s50 idxen offen offset:2048 sc1 lds
    buffer_load_dwordx4 v[138:139], s[36:39], s51 idxen offen offset:3072 sc1 lds
    v_mfma_f32_32x32x8_bf16 v[0:15], v[96:97], v[98:99], v[0:15]
K_vb14:
    v_exp_f32 v76, v44
    v_exp_f32 v77, v45
    v_exp_f32 v92, v60
    v_exp_f32 v93, v61
    v_mfma_f32_32x32x8_bf16 v[16:31], v[96:97], v[100:101], v[16:31]
    v_exp_f32 v78, v46
    v_exp_f32 v79, v47
    v_exp_f32 v94, v62
    v_exp_f32 v95, v63
    v_add_u32 v142, v144, v142
    v_add_u32 v141, 64, v141
    v_add_u32 v143, 0x200, v143
    s_lshr_b32 s34, s52, 16
    s_add_u32 s34, s34, s32
    s_addc_u32 s35, s33, 0
.p2align 3
    v_pk_fma_f32 v[110:111], v[44:45], v[104:105], v[102:103]
    v_pk_fma_f32 v[112:113], v[60:61], v[108:109], v[106:107]
    v_pk_fma_f32 v[104:105], v[104:105], v[76:77], v[104:105]
    v_pk_fma_f32 v[108:109], v[108:109], v[92:93], v[108:109]
    v_pk_fma_f32 v[102:103], v[102:103], v[76:77], v[110:111]
    v_pk_fma_f32 v[106:107], v[106:107], v[92:93], v[112:113]
    v_pk_fma_f32 v[110:111], v[46:47], v[104:105], v[102:103]
    v_pk_fma_f32 v[112:113], v[62:63], v[108:109], v[106:107]
    v_pk_fma_f32 v[104:105], v[104:105], v[78:79], v[104:105]
    v_pk_fma_f32 v[108:109], v[108:109], v[94:95], v[108:109]
    v_pk_fma_f32 v[102:103], v[102:103], v[78:79], v[110:111]
    v_pk_fma_f32 v[106:107], v[106:107], v[94:95], v[112:113]
    v_add_u32 v145, 288, v145
    s_setpc_b64 s[34:35]
.org K_vbase + 14400, 0
    s_setprio 2
    s_branch K_var15
    s_setprio 1
    s_branch K_var15
    s_mov_b64 vcc, -1
    s_branch K_var15
    s_setprio 0
    s_mov_b32 s38, 0
K_var15:
    v_exp_f32 v64, v32
    v_exp_f32 v65, v33
    v_exp_f32 v80, v48
    v_exp_f32 v81, v49
    v_exp_f32 v66, v34
    v_exp_f32 v67, v35
    v_exp_f32 v82, v50
    v_exp_f32 v83, v51
    v_exp_f32 v68, v36
    v_exp_f32 v69, v37
    v_exp_f32 v84, v52
    v_exp_f32 v85, v53
    v_exp_f32 v70, v38
    v_exp_f32 v71, v39
    v_exp_f32 v86, v54
    v_exp_f32 v87, v55
    v_exp_f32 v72, v40
    v_exp_f32 v73, v41
    v_exp_f32 v88, v56
    v_exp_f32 v89, v57
    v_exp_f32 v74, v42
    v_exp_f32 v75, v43
    v_exp_f32 v90, v58
    v_exp_f32 v91, v59
.p2align 3
    v_pk_fma_f32 v[110:111], v[32:33], v[104:105], v[102:103]
    v_pk_fma_f32 v[112:113], v[48:49], v[108:109], v[106:107]
    v_pk_fma_f32 v[104:105], v[104:105], v[64:65], v[104:105]
    v_pk_fma_f32 v[108:109], v[108:109], v[80:81], v[108:109]
    v_pk_fma_f32 v[102:103], v[102:103], v[64:65], v[110:111]
    v_pk_fma_f32 v[106:107], v[106:107], v[80:81], v[112:113]
    v_pk_fma_f32 v[110:111], v[34:35], v[104:105], v[102:103]
    v_pk_fma_f32 v[112:113], v[50:51], v[108:109], v[106:107]
    v_pk_fma_f32 v[104:105], v[104:105], v[66:67], v[104:105]
    v_pk_fma_f32 v[108:109], v[108:109], v[82:83], v[108:109]
    v_pk_fma_f32 v[102:103], v[102:103], v[66:67], v[110:111]
    v_pk_fma_f32 v[106:107], v[106:107], v[82:83], v[112:113]
    v_pk_fma_f32 v[110:111], v[36:37], v[104:105], v[102:103]
    v_pk_fma_f32 v[112:113], v[52:53], v[108:109], v[106:107]
    v_pk_fma_f32 v[104:105], v[104:105], v[68:69], v[104:105]
    v_pk_fma_f32 v[108:109], v[108:109], v[84:85], v[108:109]
    v_pk_fma_f32 v[102:103], v[102:103], v[68:69], v[110:111]
    v_pk_fma_f32 v[106:107], v[106:107], v[84:85], v[112:113]
    v_pk_fma_f32 v[110:111], v[38:39], v[104:105], v[102:103]
    v_pk_fma_f32 v[112:113], v[54:55], v[108:109], v[106:107]
    v_pk_fma_f32 v[104:105], v[104:105], v[70:71], v[104:105]
    v_pk_fma_f32 v[108:109], v[108:109], v[86:87], v[108:109]
    v_pk_fma_f32 v[102:103], v[102:103], v[70:71], v[110:111]
    v_pk_fma_f32 v[106:107], v[106:107], v[86:87], v[112:113]
    s_cbranch_vccnz K_va15
    s_waitcnt vmcnt(0)
    ds_read_b32 v96, v142 offset:128
    ds_read_b32 v97, v142 offset:14208
    ds_read_b32 v98, v143 offset:0
    ds_read_b32 v100, v143 offset:256
    ds_read_b64_tr_b16 v[0:1], v140 offset:0
    ds_read_b64_tr_b16 v[16:17], v140 offset:128
    ds_read_b64_tr_b16 v[2:3], v140 offset:512
    ds_read_b64_tr_b16 v[18:19], v140 offset:640
    ds_read_b64_tr_b16 v[4:5], v140 offset:1024
    ds_read_b64_tr_b16 v[20:21], v140 offset:1152
    ds_read_b64_tr_b16 v[6:7], v140 offset:1536
    ds_read_b64_tr_b16 v[22:23], v140 offset:1664
    ds_read_b64_tr_b16 v[8:9], v140 offset:2048
    ds_read_b64_tr_b16 v[24:25], v140 offset:2176
    ds_read_b64_tr_b16 v[10:11], v140 offset:2560
    ds_read_b64_tr_b16 v[26:27], v140 offset:2688
    ds_read_b64_tr_b16 v[12:13], v140 offset:3072
    ds_read_b64_tr_b16 v[28:29], v140 offset:3200
    ds_read_b64_tr_b16 v[14:15], v140 offset:3584
    ds_read_b64_tr_b16 v[30:31], v140 offset:3712
    ds_read_u16 v132, v141 offset:96
    ds_read_u16 v134, v141 offset:104
    ds_read_u16 v136, v141 offset:112
    ds_read_u16 v138, v141 offset:120
.p2align 3
K_va15:
.p2align 3
    v_pk_fma_f32 v[110:111], v[40:41], v[104:105], v[102:103]
    v_pk_fma_f32 v[112:113], v[56:57], v[108:109], v[106:107]
    v_pk_fma_f32 v[104:105], v[104:105], v[72:73], v[104:105]
    v_pk_fma_f32 v[108:109], v[108:109], v[88:89], v[108:109]
    v_pk_fma_f32 v[102:103], v[102:103], v[72:73], v[110:111]
    v_pk_fma_f32 v[106:107], v[106:107], v[88:89], v[112:113]
    v_rcp_f32 v114, v104
    v_rcp_f32 v115, v105
    v_rcp_f32 v116, v108
    v_rcp_f32 v117, v109
    v_pk_add_f32 v[104:105], v[74:75], 1.0 op_sel_hi:[1,0]
    v_pk_add_f32 v[108:109], v[90:91], 1.0 op_sel_hi:[1,0]
    v_pk_mul_f32 v[118:119], v[102:103], v[114:115]
    v_pk_mul_f32 v[120:121], v[106:107], v[116:117]
    v_min3_f32 v146, v146, v114, v115
    v_min3_f32 v146, v146, v116, v117
    v_add_f32 v118, v118, v119
    v_add_f32 v120, v120, v121
    v_cvt_pk_bf16_f32 v118, v118, v120
    ds_write_b32 v145, v118
    s_cbranch_vccnz K_vb15
    s_waitcnt lgkmcnt(0)
    buffer_load_dwordx4 v[132:133], s[36:39], s48 idxen offen offset:0 sc1 lds
    buffer_load_dwordx4 v[134:135], s[36:39], s49 idxen offen offset:1024 sc1 lds
    buffer_load_dwordx4 v[136:137], s[36:39], s50 idxen offen offset:2048 sc1 lds
    buffer_load_dwordx4 v[138:139], s[36:39], s51 idxen offen offset:3072 sc1 lds
    v_mfma_f32_32x32x8_bf16 v[0:15], v[96:97], v[98:99], v[0:15]
K_vb15:
    v_exp_f32 v76, v44
    v_exp_f32 v77, v45
    v_exp_f32 v92, v60
    v_exp_f32 v93, v61
    v_mfma_f32_32x32x8_bf16 v[16:31], v[96:97], v[100:101], v[16:31]
    v_exp_f32 v78, v46
    v_exp_f32 v79, v47
    v_exp_f32 v94, v62
    v_exp_f32 v95, v63
    v_add_u32 v142, v144, v142
    v_add_u32 v141, 64, v141
    v_add_u32 v143, 0x200, v143
    s_lshr_b32 s34, s52, 16
    s_add_u32 s34, s34, s32
    s_addc_u32 s35, s33, 0
.p2align 3
    v_pk_fma_f32 v[110:111], v[44:45], v[104:105], v[42:43]
    v_pk_fma_f32 v[112:113], v[60:61], v[108:109], v[58:59]
    v_pk_fma_f32 v[104:105], v[104:105], v[76:77], v[104:105]
    v_pk_fma_f32 v[108:109], v[108:109], v[92:93], v[108:109]
    v_pk_fma_f32 v[102:103], v[42:43], v[76:77], v[110:111]
    v_pk_fma_f32 v[106:107], v[58:59], v[92:93], v[112:113]
    v_pk_fma_f32 v[110:111], v[46:47], v[104:105], v[102:103]
    v_pk_fma_f32 v[112:113], v[62:63], v[108:109], v[106:107]
    v_pk_fma_f32 v[104:105], v[104:105], v[78:79], v[104:105]
    v_pk_fma_f32 v[108:109], v[108:109], v[94:95], v[108:109]
    v_pk_fma_f32 v[102:103], v[102:103], v[78:79], v[110:111]
    v_pk_fma_f32 v[106:107], v[106:107], v[94:95], v[112:113]
    v_add_u32 v145, 288, v145
    s_setpc_b64 s[34:35]
.org K_vbase + 15360, 0
    s_setprio 2
    s_branch K_var16
    s_setprio 1
    s_branch K_var16
    s_mov_b64 vcc, -1
    s_branch K_var16
    s_setprio 0
    s_mov_b32 s38, 0
K_var16:
    v_exp_f32 v64, v32
    v_exp_f32 v65, v33
    v_exp_f32 v80, v48
    v_exp_f32 v81, v49
    v_exp_f32 v66, v34
    v_exp_f32 v67, v35
    v_exp_f32 v82, v50
    v_exp_f32 v83, v51
    v_exp_f32 v68, v36
    v_exp_f32 v69, v37
    v_exp_f32 v84, v52
    v_exp_f32 v85, v53
    v_exp_f32 v70, v38
    v_exp_f32 v71, v39
    v_exp_f32 v86, v54
    v_exp_f32 v87, v55
    v_exp_f32 v72, v40
    v_exp_f32 v73, v41
    v_exp_f32 v88, v56
    v_exp_f32 v89, v57
    v_exp_f32 v74, v42
    v_exp_f32 v75, v43
    v_exp_f32 v90, v58
    v_exp_f32 v91, v59
.p2align 3
    v_pk_fma_f32 v[110:111], v[32:33], v[104:105], v[102:103]
    v_pk_fma_f32 v[112:113], v[48:49], v[108:109], v[106:107]
    v_pk_fma_f32 v[104:105], v[104:105], v[64:65], v[104:105]
    v_pk_fma_f32 v[108:109], v[108:109], v[80:81], v[108:109]
    v_pk_fma_f32 v[102:103], v[102:103], v[64:65], v[110:111]
    v_pk_fma_f32 v[106:107], v[106:107], v[80:81], v[112:113]
    v_pk_fma_f32 v[110:111], v[34:35], v[104:105], v[102:103]
    v_pk_fma_f32 v[112:113], v[50:51], v[108:109], v[106:107]
    v_pk_fma_f32 v[104:105], v[104:105], v[66:67], v[104:105]
    v_pk_fma_f32 v[108:109], v[108:109], v[82:83], v[108:109]
    v_pk_fma_f32 v[102:103], v[102:103], v[66:67], v[110:111]
    v_pk_fma_f32 v[106:107], v[106:107], v[82:83], v[112:113]
    v_pk_fma_f32 v[110:111], v[36:37], v[104:105], v[102:103]
    v_pk_fma_f32 v[112:113], v[52:53], v[108:109], v[106:107]
    v_pk_fma_f32 v[104:105], v[104:105], v[68:69], v[104:105]
    v_pk_fma_f32 v[108:109], v[108:109], v[84:85], v[108:109]
    v_pk_fma_f32 v[102:103], v[102:103], v[68:69], v[110:111]
    v_pk_fma_f32 v[106:107], v[106:107], v[84:85], v[112:113]
    v_pk_fma_f32 v[110:111], v[38:39], v[104:105], v[102:103]
    v_pk_fma_f32 v[112:113], v[54:55], v[108:109], v[106:107]
    v_pk_fma_f32 v[104:105], v[104:105], v[70:71], v[104:105]
    v_pk_fma_f32 v[108:109], v[108:109], v[86:87], v[108:109]
    v_pk_fma_f32 v[102:103], v[102:103], v[70:71], v[110:111]
    v_pk_fma_f32 v[106:107], v[106:107], v[86:87], v[112:113]
    s_cbranch_vccnz K_va16
    s_waitcnt vmcnt(0)
    ds_read_b32 v96, v142 offset:128
    ds_read_b32 v97, v142 offset:14208
    ds_read_b32 v98, v143 offset:0
    ds_read_b32 v100, v143 offset:256
    ds_read_b64_tr_b16 v[0:1], v140 offset:0
    ds_read_b64_tr_b16 v[16:17], v140 offset:128
    ds_read_b64_tr_b16 v[2:3], v140 offset:512
    ds_read_b64_tr_b16 v[18:19], v140 offset:640
    ds_read_b64_tr_b16 v[4:5], v140 offset:1024
    ds_read_b64_tr_b16 v[20:21], v140 offset:1152
    ds_read_b64_tr_b16 v[6:7], v140 offset:1536
    ds_read_b64_tr_b16 v[22:23], v140 offset:1664
    ds_read_b64_tr_b16 v[8:9], v140 offset:2048
    ds_read_b64_tr_b16 v[24:25], v140 offset:2176
    ds_read_b64_tr_b16 v[10:11], v140 offset:2560
    ds_read_b64_tr_b16 v[26:27], v140 offset:2688
    ds_read_b64_tr_b16 v[12:13], v140 offset:3072
    ds_read_b64_tr_b16 v[28:29], v140 offset:3200
    ds_read_b64_tr_b16 v[14:15], v140 offset:3584
    ds_read_b64_tr_b16 v[30:31], v140 offset:3712
    ds_read_u16 v132, v141 offset:96
    ds_read_u16 v134, v141 offset:104
    ds_read_u16 v136, v141 offset:112
    ds_read_u16 v138, v141 offset:120
.p2align 3
K_va16:
.p2align 3
    v_pk_fma_f32 v[110:111], v[40:41], v[104:105], v[102:103]
    v_pk_fma_f32 v[112:113], v[56:57], v[108:109], v[106:107]
    v_pk_fma_f32 v[104:105], v[104:105], v[72:73], v[104:105]
    v_pk_fma_f32 v[108:109], v[108:109], v[88:89], v[108:109]
    v_pk_fma_f32 v[102:103], v[102:103], v[72:73], v[110:111]
    v_pk_fma_f32 v[106:107], v[106:107], v[88:89], v[112:113]
    v_pk_fma_f32 v[110:111], v[42:43], v[104:105], v[102:103]
    v_pk_fma_f32 v[112:113], v[58:59], v[108:109], v[106:107]
    v_pk_fma_f32 v[104:105], v[104:105], v[74:75], v[104:105]
    v_pk_fma_f32 v[108:109], v[108:109], v[90:91], v[108:109]
    v_pk_fma_f32 v[102:103], v[102:103], v[74:75], v[110:111]
    v_pk_fma_f32 v[106:107], v[106:107], v[90:91], v[112:113]
    s_cbranch_vccnz K_vb16
    s_waitcnt lgkmcnt(0)
    buffer_load_dwordx4 v[132:133], s[36:39], s48 idxen offen offset:0 sc1 lds
    buffer_load_dwordx4 v[134:135], s[36:39], s49 idxen offen offset:1024 sc1 lds
    buffer_load_dwordx4 v[136:137], s[36:39], s50 idxen offen offset:2048 sc1 lds
    buffer_load_dwordx4 v[138:139], s[36:39], s51 idxen offen offset:3072 sc1 lds
    v_mfma_f32_32x32x8_bf16 v[0:15], v[96:97], v[98:99], v[0:15]
K_vb16:
    v_exp_f32 v76, v44
    v_exp_f32 v77, v45
    v_exp_f32 v92, v60
    v_exp_f32 v93, v61
    v_mfma_f32_32x32x8_bf16 v[16:31], v[96:97], v[100:101], v[16:31]
    v_exp_f32 v78, v46
    v_exp_f32 v79, v47
    v_exp_f32 v94, v62
    v_exp_f32 v95, v63
    v_add_u32 v142, v144, v142
    v_add_u32 v141, 64, v141
    v_add_u32 v143, 0x200, v143
    s_lshr_b32 s34, s52, 16
    s_add_u32 s34, s34, s32
    s_addc_u32 s35, s33, 0
.p2align 3
    v_rcp_f32 v114, v104
    v_rcp_f32 v115, v105
    v_rcp_f32 v116, v108
    v_rcp_f32 v117, v109
    v_pk_add_f32 v[104:105], v[76:77], 1.0 op_sel_hi:[1,0]
    v_pk_add_f32 v[108:109], v[92:93], 1.0 op_sel_hi:[1,0]
    v_pk_mul_f32 v[118:119], v[102:103], v[114:115]
    v_pk_mul_f32 v[120:121], v[106:107], v[116:117]
    v_min3_f32 v146, v146, v114, v115
    v_min3_f32 v146, v146, v116, v117
    v_add_f32 v118, v118, v119
    v_add_f32 v120, v120, v121
    v_cvt_pk_bf16_f32 v118, v118, v120
    ds_write_b32 v145, v118
    v_pk_fma_f32 v[110:111], v[46:47], v[104:105], v[44:45]
    v_pk_fma_f32 v[112:113], v[62:63], v[108:109], v[60:61]
    v_pk_fma_f32 v[104:105], v[104:105], v[78:79], v[104:105]
    v_pk_fma_f32 v[108:109], v[108:109], v[94:95], v[108:109]
    v_pk_fma_f32 v[102:103], v[44:45], v[78:79], v[110:111]
    v_pk_fma_f32 v[106:107], v[60:61], v[94:95], v[112:113]
    v_add_u32 v145, 288, v145
    s_setpc_b64 s[34:35]
.org K_vbase + 16320, 0
    s_setprio 2
    s_branch K_var17
    s_setprio 1
    s_branch K_var17
    s_mov_b64 vcc, -1
    s_branch K_var17
    s_setprio 0
    s_mov_b32 s38, 0
K_var17:
    v_exp_f32 v64, v32
    v_exp_f32 v65, v33
    v_exp_f32 v80, v48
    v_exp_f32 v81, v49
    v_exp_f32 v66, v34
    v_exp_f32 v67, v35
    v_exp_f32 v82, v50
    v_exp_f32 v83, v51
    v_exp_f32 v68, v36
    v_exp_f32 v69, v37
    v_exp_f32 v84, v52
    v_exp_f32 v85, v53
    v_exp_f32 v70, v38
    v_exp_f32 v71, v39
    v_exp_f32 v86, v54
    v_exp_f32 v87, v55
    v_exp_f32 v72, v40
    v_exp_f32 v73, v41
    v_exp_f32 v88, v56
    v_exp_f32 v89, v57
    v_exp_f32 v74, v42
    v_exp_f32 v75, v43
    v_exp_f32 v90, v58
    v_exp_f32 v91, v59
.p2align 3
    v_pk_fma_f32 v[110:111], v[32:33], v[104:105], v[102:103]
    v_pk_fma_f32 v[112:113], v[48:49], v[108:109], v[106:107]
    v_pk_fma_f32 v[104:105], v[104:105], v[64:65], v[104:105]
    v_pk_fma_f32 v[108:109], v[108:109], v[80:81], v[108:109]
    v_pk_fma_f32 v[102:103], v[102:103], v[64:65], v[110:111]
    v_pk_fma_f32 v[106:107], v[106:107], v[80:81], v[112:113]
    v_pk_fma_f32 v[110:111], v[34:35], v[104:105], v[102:103]
    v_pk_fma_f32 v[112:113], v[50:51], v[108:109], v[106:107]
    v_pk_fma_f32 v[104:105], v[104:105], v[66:67], v[104:105]
    v_pk_fma_f32 v[108:109], v[108:109], v[82:83], v[108:109]
    v_pk_fma_f32 v[102:103], v[102:103], v[66:67], v[110:111]
    v_pk_fma_f32 v[106:107], v[106:107], v[82:83], v[112:113]
    v_pk_fma_f32 v[110:111], v[36:37], v[104:105], v[102:103]
    v_pk_fma_f32 v[112:113], v[52:53], v[108:109], v[106:107]
    v_pk_fma_f32 v[104:105], v[104:105], v[68:69], v[104:105]
    v_pk_fma_f32 v[108:109], v[108:109], v[84:85], v[108:109]
    v_pk_fma_f32 v[102:103], v[102:103], v[68:69], v[110:111]
    v_pk_fma_f32 v[106:107], v[106:107], v[84:85], v[112:113]
    v_pk_fma_f32 v[110:111], v[38:39], v[104:105], v[102:103]
    v_pk_fma_f32 v[112:113], v[54:55], v[108:109], v[106:107]
    v_pk_fma_f32 v[104:105], v[104:105], v[70:71], v[104:105]
    v_pk_fma_f32 v[108:109], v[108:109], v[86:87], v[108:109]
    v_pk_fma_f32 v[102:103], v[102:103], v[70:71], v[110:111]
    v_pk_fma_f32 v[106:107], v[106:107], v[86:87], v[112:113]
    s_cbranch_vccnz K_va17
    s_waitcnt vmcnt(0)
    ds_read_b32 v96, v142 offset:128
    ds_read_b32 v97, v142 offset:14208
    ds_read_b32 v98, v143 offset:0
    ds_read_b32 v100, v143 offset:256
    ds_read_b64_tr_b16 v[0:1], v140 offset:0
    ds_read_b64_tr_b16 v[16:17], v140 offset:128
    ds_read_b64_tr_b16 v[2:3], v140 offset:512
    ds_read_b64_tr_b16 v[18:19], v140 offset:640
    ds_read_b64_tr_b16 v[4:5], v140 offset:1024
    ds_read_b64_tr_b16 v[20:21], v140 offset:1152
    ds_read_b64_tr_b16 v[6:7], v140 offset:1536
    ds_read_b64_tr_b16 v[22:23], v140 offset:1664
    ds_read_b64_tr_b16 v[8:9], v140 offset:2048
    ds_read_b64_tr_b16 v[24:25], v140 offset:2176
    ds_read_b64_tr_b16 v[10:11], v140 offset:2560
    ds_read_b64_tr_b16 v[26:27], v140 offset:2688
    ds_read_b64_tr_b16 v[12:13], v140 offset:3072
    ds_read_b64_tr_b16 v[28:29], v140 offset:3200
    ds_read_b64_tr_b16 v[14:15], v140 offset:3584
    ds_read_b64_tr_b16 v[30:31], v140 offset:3712
    ds_read_u16 v132, v141 offset:96
    ds_read_u16 v134, v141 offset:104
    ds_read_u16 v136, v141 offset:112
    ds_read_u16 v138, v141 offset:120
.p2align 3
K_va17:
.p2align 3
    v_pk_fma_f32 v[110:111], v[40:41], v[104:105], v[102:103]
    v_pk_fma_f32 v[112:113], v[56:57], v[108:109], v[106:107]
    v_pk_fma_f32 v[104:105], v[104:105], v[72:73], v[104:105]
    v_pk_fma_f32 v[108:109], v[108:109], v[88:89], v[108:109]
    v_pk_fma_f32 v[102:103], v[102:103], v[72:73], v[110:111]
    v_pk_fma_f32 v[106:107], v[106:107], v[88:89], v[112:113]
    v_pk_fma_f32 v[110:111], v[42:43], v[104:105], v[102:103]
    v_pk_fma_f32 v[112:113], v[58:59], v[108:109], v[106:107]
    v_pk_fma_f32 v[104:105], v[104:105], v[74:75], v[104:105]
    v_pk_fma_f32 v[108:109], v[108:109], v[90:91], v[108:109]
    v_pk_fma_f32 v[102:103], v[102:103], v[74:75], v[110:111]
    v_pk_fma_f32 v[106:107], v[106:107], v[90:91], v[112:113]
    s_cbranch_vccnz K_vb17
    s_waitcnt lgkmcnt(0)
    buffer_load_dwordx4 v[132:133], s[36:39], s48 idxen offen offset:0 sc1 lds
    buffer_load_dwordx4 v[134:135], s[36:39], s49 idxen offen offset:1024 sc1 lds
    buffer_load_dwordx4 v[136:137], s[36:39], s50 idxen offen offset:2048 sc1 lds
    buffer_load_dwordx4 v[138:139], s[36:39], s51 idxen offen offset:3072 sc1 lds
    v_mfma_f32_32x32x8_bf16 v[0:15], v[96:97], v[98:99], v[0:15]
K_vb17:
    v_exp_f32 v76, v44
    v_exp_f32 v77, v45
    v_exp_f32 v92, v60
    v_exp_f32 v93, v61
    v_mfma_f32_32x32x8_bf16 v[16:31], v[96:97], v[100:101], v[16:31]
    v_exp_f32 v78, v46
    v_exp_f32 v79, v47
    v_exp_f32 v94, v62
    v_exp_f32 v95, v63
    v_add_u32 v142, v144, v142
    v_add_u32 v141, 64, v141
    v_add_u32 v143, 0x200, v143
    s_lshr_b32 s34, s52, 16
    s_add_u32 s34, s34, s32
    s_addc_u32 s35, s33, 0
.p2align 3
    v_pk_fma_f32 v[110:111], v[44:45], v[104:105], v[102:103]
    v_pk_fma_f32 v[112:113], v[60:61], v[108:109], v[106:107]
    v_pk_fma_f32 v[104:105], v[104:105], v[76:77], v[104:105]
    v_pk_fma_f32 v[108:109], v[108:109], v[92:93], v[108:109]
    v_pk_fma_f32 v[102:103], v[102:103], v[76:77], v[110:111]
    v_pk_fma_f32 v[106:107], v[106:107], v[92:93], v[112:113]
    v_rcp_f32 v114, v104
    v_rcp_f32 v115, v105
    v_rcp_f32 v116, v108
    v_rcp_f32 v117, v109
    v_pk_add_f32 v[104:105], v[78:79], 1.0 op_sel_hi:[1,0]
    v_pk_add_f32 v[108:109], v[94:95], 1.0 op_sel_hi:[1,0]
    v_pk_mul_f32 v[118:119], v[102:103], v[114:115]
    v_pk_mul_f32 v[120:121], v[106:107], v[116:117]
    v_min3_f32 v146, v146, v114, v115
    v_min3_f32 v146, v146, v116, v117
    v_add_f32 v118, v118, v119
    v_add_f32 v120, v120, v121
    v_cvt_pk_bf16_f32 v118, v118, v120
    ds_write_b32 v145, v118
    v_pk_mov_b32 v[102:103], v[46:47], v[46:47] op_sel:[0,1]
    v_pk_mov_b32 v[106:107], v[62:63], v[62:63] op_sel:[0,1]
    v_add_u32 v145, 288, v145
    s_setpc_b64 s[34:35]
.p2align 3
K_exit:
    v_rcp_f32 v114, v104
    v_rcp_f32 v115, v105
    v_rcp_f32 v116, v108
    v_rcp_f32 v117, v109
    s_nop 0
    v_pk_mul_f32 v[118:119], v[102:103], v[114:115]
    v_pk_mul_f32 v[120:121], v[106:107], v[116:117]
    v_min3_f32 v146, v146, v114, v115
    v_min3_f32 v146, v146, v116, v117
    v_add_f32 v118, v118, v119
    v_add_f32 v120, v120, v121
    v_cvt_pk_bf16_f32 v118, v118, v120
    ds_write_b32 v145, v118
    v_cmp_eq_f32 vcc, 0, v146
    s_cbranch_vccz K_join
    v_mov_b32 v65, 536
    ds_write_b32 v65, v65
K_join:
    s_cmp_ge_u32 s29, 7
    s_cbranch_scc1 K_st2a
    ds_read_b64 v[102:103], v125 offset:52224
    s_lshl_b32 s60, s27, 7
    s_add_u32 s40, s20, s60
    s_addc_u32 s41, s21, 0
    s_lshl_b32 s42, s28, 7
    s_mov_b32 s43, 0x00020000
    s_movk_i32 s62, 0x207
    s_mov_b32 s60, 1
    v_mov_b32 v96, 0xbf317218
    v_mov_b32 v98, 2048
    s_lshl_b32 s61, s28, 3
    v_cmp_gt_u32 s[66:67], s61, v125
    s_waitcnt lgkmcnt(0)
    v_lshrrev_b32 v125, 16, v102
    v_add_u32_sdwa v100, v102, v124 dst_sel:DWORD dst_unused:UNUSED_PAD src0_sel:WORD_0 src1_sel:DWORD
    v_cmp_lt_u32 vcc, 0, v125
    v_add_u32 v124, 272, v100
    v_cndmask_b32 v100, v98, v100, s[66:67]
    v_pk_mul_f32 v[128:129], v[128:129], v[102:103] op_sel:[0,1]
    v_pk_mul_f32 v[130:131], v[130:131], v[102:103] op_sel:[0,1]
    v_pk_mul_f32 v[122:123], v[122:123], v[102:103] op_sel:[0,1]
    v_pk_mul_f32 v[152:153], v[152:153], v[102:103] op_sel:[0,1]
    v_cndmask_b32 v101, v98, v124, vcc
    s_cmp_ge_u32 s29, 4
    s_cbranch_scc1 K_st2a
    ds_read_b64_tr_b16 v[0:1], v147 offset:0
    ds_read_b64_tr_b16 v[2:3], v147 offset:256
    ds_read_b64_tr_b16 v[4:5], v147 offset:2048
    ds_read_b64_tr_b16 v[6:7], v147 offset:2304
    ds_read_b64_tr_b16 v[8:9], v147 offset:4096
    ds_read_b64_tr_b16 v[10:11], v147 offset:4352
    ds_read_b64_tr_b16 v[12:13], v147 offset:6144
    ds_read_b64_tr_b16 v[14:15], v147 offset:6400
    ds_read_b64_tr_b16 v[16:17], v147 offset:8
    ds_read_b64_tr_b16 v[18:19], v147 offset:264
    ds_read_b64_tr_b16 v[20:21], v147 offset:2056
    ds_read_b64_tr_b16 v[22:23], v147 offset:2312
    ds_read_b64_tr_b16 v[24:25], v147 offset:4104
    ds_read_b64_tr_b16 v[26:27], v147 offset:4360
    ds_read_b64_tr_b16 v[28:29], v147 offset:6152
    ds_read_b64_tr_b16 v[30:31], v147 offset:6408
    ds_read_b64_tr_b16 v[32:33], v147 offset:64
    ds_read_b64_tr_b16 v[34:35], v147 offset:320
    ds_read_b64_tr_b16 v[36:37], v147 offset:2112
    ds_read_b64_tr_b16 v[38:39], v147 offset:2368
    ds_read_b64_tr_b16 v[40:41], v147 offset:4160
    ds_read_b64_tr_b16 v[42:43], v147 offset:4416
    ds_read_b64_tr_b16 v[44:45], v147 offset:6208
    ds_read_b64_tr_b16 v[46:47], v147 offset:6464
    ds_read_b64_tr_b16 v[48:49], v147 offset:72
    ds_read_b64_tr_b16 v[50:51], v147 offset:328
    ds_read_b64_tr_b16 v[52:53], v147 offset:2120
    ds_read_b64_tr_b16 v[54:55], v147 offset:2376
    ds_read_b64_tr_b16 v[56:57], v147 offset:4168
    ds_read_b64_tr_b16 v[58:59], v147 offset:4424
    ds_read_b64_tr_b16 v[60:61], v147 offset:6216
    ds_read_b64_tr_b16 v[62:63], v147 offset:6472
    s_waitcnt lgkmcnt(0)
    s_barrier
    ds_read_b128 v[64:67], v164 offset:0
    ds_read_b128 v[68:71], v164 offset:64
    ds_read_b128 v[72:75], v164 offset:128
    ds_read_b128 v[76:79], v164 offset:192
    s_waitcnt lgkmcnt(3)
    v_mfma_f32_16x16x32_bf16 v[80:83], v[0:3], v[64:67], 0
    v_mfma_f32_16x16x32_bf16 v[84:87], v[16:19], v[64:67], 0
    s_waitcnt lgkmcnt(2)
    v_mfma_f32_16x16x32_bf16 v[80:83], v[4:7], v[68:71], v[80:83]
    v_mfma_f32_16x16x32_bf16 v[84:87], v[20:23], v[68:71], v[84:87]
    s_waitcnt lgkmcnt(1)
    v_mfma_f32_16x16x32_bf16 v[80:83], v[8:11], v[72:75], v[80:83]
    v_mfma_f32_16x16x32_bf16 v[84:87], v[24:27], v[72:75], v[84:87]
    s_waitcnt lgkmcnt(0)
    v_mfma_f32_16x16x32_bf16 v[80:83], v[12:15], v[76:79], v[80:83]
    v_mfma_f32_16x16x32_bf16 v[84:87], v[28:31], v[76:79], v[84:87]
    v_mfma_f32_16x16x32_bf16 v[88:91], v[32:35], v[64:67], 0
    v_mfma_f32_16x16x32_bf16 v[92:95], v[48:51], v[64:67], 0
    v_mfma_f32_16x16x32_bf16 v[88:91], v[36:39], v[68:71], v[88:91]
    v_mfma_f32_16x16x32_bf16 v[92:95], v[52:55], v[68:71], v[92:95]
    v_mfma_f32_16x16x32_bf16 v[88:91], v[40:43], v[72:75], v[88:91]
    v_mfma_f32_16x16x32_bf16 v[92:95], v[56:59], v[72:75], v[92:95]
    v_mfma_f32_16x16x32_bf16 v[88:91], v[44:47], v[76:79], v[88:91]
    v_mfma_f32_16x16x32_bf16 v[92:95], v[60:63], v[76:79], v[92:95]
    ds_write_b128 v165, v[80:83]
    ds_write_b128 v165, v[84:87] offset:16
    s_nop 4
    ds_write_b128 v165, v[88:91] offset:128
    ds_write_b128 v165, v[92:95] offset:144
    s_waitcnt lgkmcnt(0)
    s_branch K_st2b
K_st2a:
    s_waitcnt lgkmcnt(0)
    s_barrier
K_st2b:
    s_cmp_ge_u32 s29, 7
    s_barrier
    s_cbranch_scc1 K_fin
    ds_read_b128 v[64:67], v100
    ds_read_b128 v[68:71], v100 offset:16
K_rows:
    ds_read_b128 v[72:75], v101
    ds_read_b128 v[76:79], v101 offset:16
    v_cmp_lt_u32 vcc, s60, v125
    v_add_u32 v124, 272, v124
    s_add_u32 s60, s60, 1
    s_waitcnt lgkmcnt(0)
    v_pk_add_f32 v[64:65], v[64:65], v[72:73]
    v_pk_add_f32 v[66:67], v[66:67], v[74:75]
    v_pk_add_f32 v[68:69], v[68:69], v[76:77]
    v_pk_add_f32 v[70:71], v[70:71], v[78:79]
    v_cndmask_b32 v101, v98, v124, vcc
    s_cbranch_vccnz K_rows
    v_pk_fma_f32 v[64:65], v[64:65], v[96:97], v[128:129] op_sel_hi:[1,0,1]
    v_pk_fma_f32 v[66:67], v[66:67], v[96:97], v[130:131] op_sel_hi:[1,0,1]
    v_pk_fma_f32 v[68:69], v[68:69], v[96:97], v[122:123] op_sel_hi:[1,0,1]
    v_pk_fma_f32 v[70:71], v[70:71], v[96:97], v[152:153] op_sel_hi:[1,0,1]
    v_cvt_pk_bf16_f32 v72, v64, v65
    v_cvt_pk_bf16_f32 v73, v66, v67
    v_cvt_pk_bf16_f32 v74, v68, v69
    v_cvt_pk_bf16_f32 v75, v70, v71
    buffer_store_dwordx4 v[72:75], v127, s[40:43], 0 offen sc1
    v_cmp_class_f32 vcc, v64, s62
    s_cbranch_vccz K_fin
    v_mov_b32 v65, 536
    ds_write_b32 v65, v65
K_fin:
    v_mov_b32 v65, 536
    s_waitcnt lgkmcnt(0)
    s_barrier
    ds_read_b32 v64, v65
    s_waitcnt lgkmcnt(0)
    v_cmp_ne_u32 vcc, 0, v64
    s_cbranch_vccnz K_slow
K_end:
    s_endpgm
K_slow:
    s_setprio 0
    s_mov_b32 s16, s27
    s_mov_b32 s17, s28
    s_mov_b32 s18, s29
SL_start:
    s_mov_b64 exec, -1
    s_waitcnt vmcnt(0) lgkmcnt(0)
    s_barrier
    s_load_dwordx8 s[4:11], s[0:1], 0
    s_load_dwordx4 s[12:15], s[0:1], 32
    s_load_dwordx4 s[20:23], s[0:1], 48
    s_load_dwordx2 s[24:25], s[0:1], 64
    s_lshl_b32 s26, s18, 10
    v_lshl_add_u32 v140, v154, 4, s26
    v_mov_b32 v144, 0
    v_mov_b32 v145, 0
    v_mov_b32 v146, 0
    v_mov_b32 v147, 0
    ds_write_b128 v140, v[144:147] offset:0
    ds_write_b128 v140, v[144:147] offset:12288
    ds_write_b128 v140, v[144:147] offset:24576
    v_lshlrev_b32 v141, 2, v154
    s_waitcnt lgkmcnt(0)
    v_mov_b32 v142, v141
    s_mov_b32 s26, 0x05040100
    s_mov_b32 s27, 0x07060302
    global_load_dword v0, v142, s[12:13] offset:0
    global_load_dword v1, v142, s[12:13] offset:256
    global_load_dword v2, v142, s[12:13] offset:512
    global_load_dword v3, v142, s[12:13] offset:768
    global_load_dword v4, v142, s[12:13] offset:1024
    global_load_dword v5, v142, s[12:13] offset:1280
    global_load_dword v6, v142, s[12:13] offset:1536
    global_load_dword v7, v142, s[12:13] offset:1792
    global_load_dword v8, v142, s[12:13] offset:2048
    global_load_dword v9, v142, s[12:13] offset:2304
    global_load_dword v10, v142, s[12:13] offset:2560
    global_load_dword v11, v142, s[12:13] offset:2816
    global_load_dword v12, v142, s[12:13] offset:3072
    global_load_dword v13, v142, s[12:13] offset:3328
    global_load_dword v14, v142, s[12:13] offset:3584
    global_load_dword v15, v142, s[12:13] offset:3840
    v_add_u32 v142, 0x1000, v142
    s_waitcnt vmcnt(0)
    v_perm_b32 v143, v1, v0, s26
    v_perm_b32 v1, v1, v0, s27
    v_mov_b32 v0, v143
    v_perm_b32 v143, v3, v2, s26
    v_perm_b32 v3, v3, v2, s27
    v_mov_b32 v2, v143
    v_perm_b32 v143, v5, v4, s26
    v_perm_b32 v5, v5, v4, s27
    v_mov_b32 v4, v143
    v_perm_b32 v143, v7, v6, s26
    v_perm_b32 v7, v7, v6, s27
    v_mov_b32 v6, v143
    v_perm_b32 v143, v9, v8, s26
    v_perm_b32 v9, v9, v8, s27
    v_mov_b32 v8, v143
    v_perm_b32 v143, v11, v10, s26
    v_perm_b32 v11, v11, v10, s27
    v_mov_b32 v10, v143
    v_perm_b32 v143, v13, v12, s26
    v_perm_b32 v13, v13, v12, s27
    v_mov_b32 v12, v143
    v_perm_b32 v143, v15, v14, s26
    v_perm_b32 v15, v15, v14, s27
    v_mov_b32 v14, v143
    global_load_dword v16, v142, s[12:13] offset:0
    global_load_dword v17, v142, s[12:13] offset:256
    global_load_dword v18, v142, s[12:13] offset:512
    global_load_dword v19, v142, s[12:13] offset:768
    global_load_dword v20, v142, s[12:13] offset:1024
    global_load_dword v21, v142, s[12:13] offset:1280
    global_load_dword v22, v142, s[12:13] offset:1536
    global_load_dword v23, v142, s[12:13] offset:1792
    global_load_dword v24, v142, s[12:13] offset:2048
    global_load_dword v25, v142, s[12:13] offset:2304
    global_load_dword v26, v142, s[12:13] offset:2560
    global_load_dword v27, v142, s[12:13] offset:2816
    global_load_dword v28, v142, s[12:13] offset:3072
    global_load_dword v29, v142, s[12:13] offset:3328
    global_load_dword v30, v142, s[12:13] offset:3584
    global_load_dword v31, v142, s[12:13] offset:3840
    v_add_u32 v142, 0x1000, v142
    s_waitcnt vmcnt(0)
    v_perm_b32 v143, v17, v16, s26
    v_perm_b32 v17, v17, v16, s27
    v_mov_b32 v16, v143
    v_perm_b32 v143, v19, v18, s26
    v_perm_b32 v19, v19, v18, s27
    v_mov_b32 v18, v143
    v_perm_b32 v143, v21, v20, s26
    v_perm_b32 v21, v21, v20, s27
    v_mov_b32 v20, v143
    v_perm_b32 v143, v23, v22, s26
    v_perm_b32 v23, v23, v22, s27
    v_mov_b32 v22, v143
    v_perm_b32 v143, v25, v24, s26
    v_perm_b32 v25, v25, v24, s27
    v_mov_b32 v24, v143
    v_perm_b32 v143, v27, v26, s26
    v_perm_b32 v27, v27, v26, s27
    v_mov_b32 v26, v143
    v_perm_b32 v143, v29, v28, s26
    v_perm_b32 v29, v29, v28, s27
    v_mov_b32 v28, v143
    v_perm_b32 v143, v31, v30, s26
    v_perm_b32 v31, v31, v30, s27
    v_mov_b32 v30, v143
    global_load_dword v32, v142, s[12:13] offset:0
    global_load_dword v33, v142, s[12:13] offset:256
    global_load_dword v34, v142, s[12:13] offset:512
    global_load_dword v35, v142, s[12:13] offset:768
    global_load_dword v36, v142, s[12:13] offset:1024
    global_load_dword v37, v142, s[12:13] offset:1280
    global_load_dword v38, v142, s[12:13] offset:1536
    global_load_dword v39, v142, s[12:13] offset:1792
    global_load_dword v40, v142, s[12:13] offset:2048
    global_load_dword v41, v142, s[12:13] offset:2304
    global_load_dword v42, v142, s[12:13] offset:2560
    global_load_dword v43, v142, s[12:13] offset:2816
    global_load_dword v44, v142, s[12:13] offset:3072
    global_load_dword v45, v142, s[12:13] offset:3328
    global_load_dword v46, v142, s[12:13] offset:3584
    global_load_dword v47, v142, s[12:13] offset:3840
    v_add_u32 v142, 0x1000, v142
    s_waitcnt vmcnt(0)
    v_perm_b32 v143, v33, v32, s26
    v_perm_b32 v33, v33, v32, s27
    v_mov_b32 v32, v143
    v_perm_b32 v143, v35, v34, s26
    v_perm_b32 v35, v35, v34, s27
    v_mov_b32 v34, v143
    v_perm_b32 v143, v37, v36, s26
    v_perm_b32 v37, v37, v36, s27
    v_mov_b32 v36, v143
    v_perm_b32 v143, v39, v38, s26
    v_perm_b32 v39, v39, v38, s27
    v_mov_b32 v38, v143
    v_perm_b32 v143, v41, v40, s26
    v_perm_b32 v41, v41, v40, s27
    v_mov_b32 v40, v143
    v_perm_b32 v143, v43, v42, s26
    v_perm_b32 v43, v43, v42, s27
    v_mov_b32 v42, v143
    v_perm_b32 v143, v45, v44, s26
    v_perm_b32 v45, v45, v44, s27
    v_mov_b32 v44, v143
    v_perm_b32 v143, v47, v46, s26
    v_perm_b32 v47, v47, v46, s27
    v_mov_b32 v46, v143
    global_load_dword v48, v142, s[12:13] offset:0
    global_load_dword v49, v142, s[12:13] offset:256
    global_load_dword v50, v142, s[12:13] offset:512
    global_load_dword v51, v142, s[12:13] offset:768
    global_load_dword v52, v142, s[12:13] offset:1024
    global_load_dword v53, v142, s[12:13] offset:1280
    global_load_dword v54, v142, s[12:13] offset:1536
    global_load_dword v55, v142, s[12:13] offset:1792
    global_load_dword v56, v142, s[12:13] offset:2048
    global_load_dword v57, v142, s[12:13] offset:2304
    global_load_dword v58, v142, s[12:13] offset:2560
    global_load_dword v59, v142, s[12:13] offset:2816
    global_load_dword v60, v142, s[12:13] offset:3072
    global_load_dword v61, v142, s[12:13] offset:3328
    global_load_dword v62, v142, s[12:13] offset:3584
    global_load_dword v63, v142, s[12:13] offset:3840
    v_add_u32 v142, 0x1000, v142
    s_waitcnt vmcnt(0)
    v_perm_b32 v143, v49, v48, s26
    v_perm_b32 v49, v49, v48, s27
    v_mov_b32 v48, v143
    v_perm_b32 v143, v51, v50, s26
    v_perm_b32 v51, v51, v50, s27
    v_mov_b32 v50, v143
    v_perm_b32 v143, v53, v52, s26
    v_perm_b32 v53, v53, v52, s27
    v_mov_b32 v52, v143
    v_perm_b32 v143, v55, v54, s26
    v_perm_b32 v55, v55, v54, s27
    v_mov_b32 v54, v143
    v_perm_b32 v143, v57, v56, s26
    v_perm_b32 v57, v57, v56, s27
    v_mov_b32 v56, v143
    v_perm_b32 v143, v59, v58, s26
    v_perm_b32 v59, v59, v58, s27
    v_mov_b32 v58, v143
    v_perm_b32 v143, v61, v60, s26
    v_perm_b32 v61, v61, v60, s27
    v_mov_b32 v60, v143
    v_perm_b32 v143, v63, v62, s26
    v_perm_b32 v63, v63, v62, s27
    v_mov_b32 v62, v143
    global_load_dword v64, v142, s[12:13] offset:0
    global_load_dword v65, v142, s[12:13] offset:256
    global_load_dword v66, v142, s[12:13] offset:512
    global_load_dword v67, v142, s[12:13] offset:768
    global_load_dword v68, v142, s[12:13] offset:1024
    global_load_dword v69, v142, s[12:13] offset:1280
    global_load_dword v70, v142, s[12:13] offset:1536
    global_load_dword v71, v142, s[12:13] offset:1792
    global_load_dword v72, v142, s[12:13] offset:2048
    global_load_dword v73, v142, s[12:13] offset:2304
    global_load_dword v74, v142, s[12:13] offset:2560
    global_load_dword v75, v142, s[12:13] offset:2816
    global_load_dword v76, v142, s[12:13] offset:3072
    global_load_dword v77, v142, s[12:13] offset:3328
    global_load_dword v78, v142, s[12:13] offset:3584
    global_load_dword v79, v142, s[12:13] offset:3840
    v_add_u32 v142, 0x1000, v142
    s_waitcnt vmcnt(0)
    v_perm_b32 v143, v65, v64, s26
    v_perm_b32 v65, v65, v64, s27
    v_mov_b32 v64, v143
    v_perm_b32 v143, v67, v66, s26
    v_perm_b32 v67, v67, v66, s27
    v_mov_b32 v66, v143
    v_perm_b32 v143, v69, v68, s26
    v_perm_b32 v69, v69, v68, s27
    v_mov_b32 v68, v143
    v_perm_b32 v143, v71, v70, s26
    v_perm_b32 v71, v71, v70, s27
    v_mov_b32 v70, v143
    v_perm_b32 v143, v73, v72, s26
    v_perm_b32 v73, v73, v72, s27
    v_mov_b32 v72, v143
    v_perm_b32 v143, v75, v74, s26
    v_perm_b32 v75, v75, v74, s27
    v_mov_b32 v74, v143
    v_perm_b32 v143, v77, v76, s26
    v_perm_b32 v77, v77, v76, s27
    v_mov_b32 v76, v143
    v_perm_b32 v143, v79, v78, s26
    v_perm_b32 v79, v79, v78, s27
    v_mov_b32 v78, v143
    global_load_dword v80, v142, s[12:13] offset:0
    global_load_dword v81, v142, s[12:13] offset:256
    global_load_dword v82, v142, s[12:13] offset:512
    global_load_dword v83, v142, s[12:13] offset:768
    global_load_dword v84, v142, s[12:13] offset:1024
    global_load_dword v85, v142, s[12:13] offset:1280
    global_load_dword v86, v142, s[12:13] offset:1536
    global_load_dword v87, v142, s[12:13] offset:1792
    global_load_dword v88, v142, s[12:13] offset:2048
    global_load_dword v89, v142, s[12:13] offset:2304
    global_load_dword v90, v142, s[12:13] offset:2560
    global_load_dword v91, v142, s[12:13] offset:2816
    global_load_dword v92, v142, s[12:13] offset:3072
    global_load_dword v93, v142, s[12:13] offset:3328
    global_load_dword v94, v142, s[12:13] offset:3584
    global_load_dword v95, v142, s[12:13] offset:3840
    v_add_u32 v142, 0x1000, v142
    s_waitcnt vmcnt(0)
    v_perm_b32 v143, v81, v80, s26
    v_perm_b32 v81, v81, v80, s27
    v_mov_b32 v80, v143
    v_perm_b32 v143, v83, v82, s26
    v_perm_b32 v83, v83, v82, s27
    v_mov_b32 v82, v143
    v_perm_b32 v143, v85, v84, s26
    v_perm_b32 v85, v85, v84, s27
    v_mov_b32 v84, v143
    v_perm_b32 v143, v87, v86, s26
    v_perm_b32 v87, v87, v86, s27
    v_mov_b32 v86, v143
    v_perm_b32 v143, v89, v88, s26
    v_perm_b32 v89, v89, v88, s27
    v_mov_b32 v88, v143
    v_perm_b32 v143, v91, v90, s26
    v_perm_b32 v91, v91, v90, s27
    v_mov_b32 v90, v143
    v_perm_b32 v143, v93, v92, s26
    v_perm_b32 v93, v93, v92, s27
    v_mov_b32 v92, v143
    v_perm_b32 v143, v95, v94, s26
    v_perm_b32 v95, v95, v94, s27
    v_mov_b32 v94, v143
    global_load_dword v96, v142, s[12:13] offset:0
    global_load_dword v97, v142, s[12:13] offset:256
    global_load_dword v98, v142, s[12:13] offset:512
    global_load_dword v99, v142, s[12:13] offset:768
    global_load_dword v100, v142, s[12:13] offset:1024
    global_load_dword v101, v142, s[12:13] offset:1280
    global_load_dword v102, v142, s[12:13] offset:1536
    global_load_dword v103, v142, s[12:13] offset:1792
    global_load_dword v104, v142, s[12:13] offset:2048
    global_load_dword v105, v142, s[12:13] offset:2304
    global_load_dword v106, v142, s[12:13] offset:2560
    global_load_dword v107, v142, s[12:13] offset:2816
    global_load_dword v108, v142, s[12:13] offset:3072
    global_load_dword v109, v142, s[12:13] offset:3328
    global_load_dword v110, v142, s[12:13] offset:3584
    global_load_dword v111, v142, s[12:13] offset:3840
    v_add_u32 v142, 0x1000, v142
    s_waitcnt vmcnt(0)
    v_perm_b32 v143, v97, v96, s26
    v_perm_b32 v97, v97, v96, s27
    v_mov_b32 v96, v143
    v_perm_b32 v143, v99, v98, s26
    v_perm_b32 v99, v99, v98, s27
    v_mov_b32 v98, v143
    v_perm_b32 v143, v101, v100, s26
    v_perm_b32 v101, v101, v100, s27
    v_mov_b32 v100, v143
    v_perm_b32 v143, v103, v102, s26
    v_perm_b32 v103, v103, v102, s27
    v_mov_b32 v102, v143
    v_perm_b32 v143, v105, v104, s26
    v_perm_b32 v105, v105, v104, s27
    v_mov_b32 v104, v143
    v_perm_b32 v143, v107, v106, s26
    v_perm_b32 v107, v107, v106, s27
    v_mov_b32 v106, v143
    v_perm_b32 v143, v109, v108, s26
    v_perm_b32 v109, v109, v108, s27
    v_mov_b32 v108, v143
    v_perm_b32 v143, v111, v110, s26
    v_perm_b32 v111, v111, v110, s27
    v_mov_b32 v110, v143
    global_load_dword v112, v142, s[12:13] offset:0
    global_load_dword v113, v142, s[12:13] offset:256
    global_load_dword v114, v142, s[12:13] offset:512
    global_load_dword v115, v142, s[12:13] offset:768
    global_load_dword v116, v142, s[12:13] offset:1024
    global_load_dword v117, v142, s[12:13] offset:1280
    global_load_dword v118, v142, s[12:13] offset:1536
    global_load_dword v119, v142, s[12:13] offset:1792
    global_load_dword v120, v142, s[12:13] offset:2048
    global_load_dword v121, v142, s[12:13] offset:2304
    global_load_dword v122, v142, s[12:13] offset:2560
    global_load_dword v123, v142, s[12:13] offset:2816
    global_load_dword v124, v142, s[12:13] offset:3072
    global_load_dword v125, v142, s[12:13] offset:3328
    global_load_dword v126, v142, s[12:13] offset:3584
    global_load_dword v127, v142, s[12:13] offset:3840
    v_add_u32 v142, 0x1000, v142
    s_waitcnt vmcnt(0)
    v_perm_b32 v143, v113, v112, s26
    v_perm_b32 v113, v113, v112, s27
    v_mov_b32 v112, v143
    v_perm_b32 v143, v115, v114, s26
    v_perm_b32 v115, v115, v114, s27
    v_mov_b32 v114, v143
    v_perm_b32 v143, v117, v116, s26
    v_perm_b32 v117, v117, v116, s27
    v_mov_b32 v116, v143
    v_perm_b32 v143, v119, v118, s26
    v_perm_b32 v119, v119, v118, s27
    v_mov_b32 v118, v143
    v_perm_b32 v143, v121, v120, s26
    v_perm_b32 v121, v121, v120, s27
    v_mov_b32 v120, v143
    v_perm_b32 v143, v123, v122, s26
    v_perm_b32 v123, v123, v122, s27
    v_mov_b32 v122, v143
    v_perm_b32 v143, v125, v124, s26
    v_perm_b32 v125, v125, v124, s27
    v_mov_b32 v124, v143
    v_perm_b32 v143, v127, v126, s26
    v_perm_b32 v127, v127, v126, s27
    v_mov_b32 v126, v143
    global_load_dword v129, v142, s[12:13]
    global_load_dword v131, v141, s[14:15]
    s_waitcnt vmcnt(0)
    v_lshlrev_b32 v128, 16, v129
    v_and_b32 v129, 0xffff0000, v129
    v_lshlrev_b32 v130, 16, v131
    v_and_b32 v131, 0xffff0000, v131
    v_lshlrev_b32 v139, 3, v154
    v_mov_b32 v148, 1
    s_barrier
    s_mov_b32 s28, s18
SL_scan:
    s_lshl_b32 s26, s28, 8
    v_add_u32 v142, s26, v141
    v_lshrrev_b32 v143, 1, v142
    global_load_dword v132, v142, s[10:11]
    global_load_dword v133, v142, s[8:9]
    global_load_ushort v134, v143, s[6:7]
    s_waitcnt vmcnt(0)
    v_subrev_u32 v135, s16, v132
    v_cmp_gt_u32 s[30:31], s17, v135
    s_nop 1
SL_edge:
    s_cmp_eq_u64 s[30:31], 0
    s_cbranch_scc1 SL_next
    s_ff1_i32_b64 s26, s[30:31]
    s_bitset0_b64 s[30:31], s26
    v_readlane_b32 s32, v133, s26
    v_readlane_b32 s33, v132, s26
    v_readlane_b32 s34, v134, s26
    v_readlane_b32 s35, v135, s26
    s_lshl_b32 s32, s32, 7
    s_lshl_b32 s33, s33, 7
    s_lshl_b32 s34, s34, 16
    s_load_dwordx16 s[36:51], s[4:5], s32
    s_load_dwordx16 s[68:83], s[4:5], s33
    s_add_u32 s32, s32, 64
    s_add_u32 s33, s33, 64
    s_load_dwordx16 s[52:67], s[4:5], s32
    s_load_dwordx16 s[84:99], s[4:5], s33
    v_fma_f32 v136, s34, v128, v130
    v_fma_f32 v137, s34, v129, v131
    s_lshl_b32 s26, s35, 9
    v_add_u32 v138, s26, v139
    s_lshl_b32 s26, s35, 2
    s_add_u32 s26, s26, 32768
    v_mov_b32 v140, s26
    s_waitcnt lgkmcnt(0)
    v_dot2_f32_bf16 v136, s36, v0, v136
    v_dot2_f32_bf16 v137, s36, v1, v137
    v_dot2_f32_bf16 v136, s37, v2, v136
    v_dot2_f32_bf16 v137, s37, v3, v137
    v_dot2_f32_bf16 v136, s38, v4, v136
    v_dot2_f32_bf16 v137, s38, v5, v137
    v_dot2_f32_bf16 v136, s39, v6, v136
    v_dot2_f32_bf16 v137, s39, v7, v137
    v_dot2_f32_bf16 v136, s40, v8, v136
    v_dot2_f32_bf16 v137, s40, v9, v137
    v_dot2_f32_bf16 v136, s41, v10, v136
    v_dot2_f32_bf16 v137, s41, v11, v137
    v_dot2_f32_bf16 v136, s42, v12, v136
    v_dot2_f32_bf16 v137, s42, v13, v137
    v_dot2_f32_bf16 v136, s43, v14, v136
    v_dot2_f32_bf16 v137, s43, v15, v137
    v_dot2_f32_bf16 v136, s44, v16, v136
    v_dot2_f32_bf16 v137, s44, v17, v137
    v_dot2_f32_bf16 v136, s45, v18, v136
    v_dot2_f32_bf16 v137, s45, v19, v137
    v_dot2_f32_bf16 v136, s46, v20, v136
    v_dot2_f32_bf16 v137, s46, v21, v137
    v_dot2_f32_bf16 v136, s47, v22, v136
    v_dot2_f32_bf16 v137, s47, v23, v137
    v_dot2_f32_bf16 v136, s48, v24, v136
    v_dot2_f32_bf16 v137, s48, v25, v137
    v_dot2_f32_bf16 v136, s49, v26, v136
    v_dot2_f32_bf16 v137, s49, v27, v137
    v_dot2_f32_bf16 v136, s50, v28, v136
    v_dot2_f32_bf16 v137, s50, v29, v137
    v_dot2_f32_bf16 v136, s51, v30, v136
    v_dot2_f32_bf16 v137, s51, v31, v137
    v_dot2_f32_bf16 v136, s52, v32, v136
    v_dot2_f32_bf16 v137, s52, v33, v137
    v_dot2_f32_bf16 v136, s53, v34, v136
    v_dot2_f32_bf16 v137, s53, v35, v137
    v_dot2_f32_bf16 v136, s54, v36, v136
    v_dot2_f32_bf16 v137, s54, v37, v137
    v_dot2_f32_bf16 v136, s55, v38, v136
    v_dot2_f32_bf16 v137, s55, v39, v137
    v_dot2_f32_bf16 v136, s56, v40, v136
    v_dot2_f32_bf16 v137, s56, v41, v137
    v_dot2_f32_bf16 v136, s57, v42, v136
    v_dot2_f32_bf16 v137, s57, v43, v137
    v_dot2_f32_bf16 v136, s58, v44, v136
    v_dot2_f32_bf16 v137, s58, v45, v137
    v_dot2_f32_bf16 v136, s59, v46, v136
    v_dot2_f32_bf16 v137, s59, v47, v137
    v_dot2_f32_bf16 v136, s60, v48, v136
    v_dot2_f32_bf16 v137, s60, v49, v137
    v_dot2_f32_bf16 v136, s61, v50, v136
    v_dot2_f32_bf16 v137, s61, v51, v137
    v_dot2_f32_bf16 v136, s62, v52, v136
    v_dot2_f32_bf16 v137, s62, v53, v137
    v_dot2_f32_bf16 v136, s63, v54, v136
    v_dot2_f32_bf16 v137, s63, v55, v137
    v_dot2_f32_bf16 v136, s64, v56, v136
    v_dot2_f32_bf16 v137, s64, v57, v137
    v_dot2_f32_bf16 v136, s65, v58, v136
    v_dot2_f32_bf16 v137, s65, v59, v137
    v_dot2_f32_bf16 v136, s66, v60, v136
    v_dot2_f32_bf16 v137, s66, v61, v137
    v_dot2_f32_bf16 v136, s67, v62, v136
    v_dot2_f32_bf16 v137, s67, v63, v137
    v_dot2_f32_bf16 v136, s68, v64, v136
    v_dot2_f32_bf16 v137, s68, v65, v137
    v_dot2_f32_bf16 v136, s69, v66, v136
    v_dot2_f32_bf16 v137, s69, v67, v137
    v_dot2_f32_bf16 v136, s70, v68, v136
    v_dot2_f32_bf16 v137, s70, v69, v137
    v_dot2_f32_bf16 v136, s71, v70, v136
    v_dot2_f32_bf16 v137, s71, v71, v137
    v_dot2_f32_bf16 v136, s72, v72, v136
    v_dot2_f32_bf16 v137, s72, v73, v137
    v_dot2_f32_bf16 v136, s73, v74, v136
    v_dot2_f32_bf16 v137, s73, v75, v137
    v_dot2_f32_bf16 v136, s74, v76, v136
    v_dot2_f32_bf16 v137, s74, v77, v137
    v_dot2_f32_bf16 v136, s75, v78, v136
    v_dot2_f32_bf16 v137, s75, v79, v137
    v_dot2_f32_bf16 v136, s76, v80, v136
    v_dot2_f32_bf16 v137, s76, v81, v137
    v_dot2_f32_bf16 v136, s77, v82, v136
    v_dot2_f32_bf16 v137, s77, v83, v137
    v_dot2_f32_bf16 v136, s78, v84, v136
    v_dot2_f32_bf16 v137, s78, v85, v137
    v_dot2_f32_bf16 v136, s79, v86, v136
    v_dot2_f32_bf16 v137, s79, v87, v137
    v_dot2_f32_bf16 v136, s80, v88, v136
    v_dot2_f32_bf16 v137, s80, v89, v137
    v_dot2_f32_bf16 v136, s81, v90, v136
    v_dot2_f32_bf16 v137, s81, v91, v137
    v_dot2_f32_bf16 v136, s82, v92, v136
    v_dot2_f32_bf16 v137, s82, v93, v137
    v_dot2_f32_bf16 v136, s83, v94, v136
    v_dot2_f32_bf16 v137, s83, v95, v137
    v_dot2_f32_bf16 v136, s84, v96, v136
    v_dot2_f32_bf16 v137, s84, v97, v137
    v_dot2_f32_bf16 v136, s85, v98, v136
    v_dot2_f32_bf16 v137, s85, v99, v137
    v_dot2_f32_bf16 v136, s86, v100, v136
    v_dot2_f32_bf16 v137, s86, v101, v137
    v_dot2_f32_bf16 v136, s87, v102, v136
    v_dot2_f32_bf16 v137, s87, v103, v137
    v_dot2_f32_bf16 v136, s88, v104, v136
    v_dot2_f32_bf16 v137, s88, v105, v137
    v_dot2_f32_bf16 v136, s89, v106, v136
    v_dot2_f32_bf16 v137, s89, v107, v137
    v_dot2_f32_bf16 v136, s90, v108, v136
    v_dot2_f32_bf16 v137, s90, v109, v137
    v_dot2_f32_bf16 v136, s91, v110, v136
    v_dot2_f32_bf16 v137, s91, v111, v137
    v_dot2_f32_bf16 v136, s92, v112, v136
    v_dot2_f32_bf16 v137, s92, v113, v137
    v_dot2_f32_bf16 v136, s93, v114, v136
    v_dot2_f32_bf16 v137, s93, v115, v137
    v_dot2_f32_bf16 v136, s94, v116, v136
    v_dot2_f32_bf16 v137, s94, v117, v137
    v_dot2_f32_bf16 v136, s95, v118, v136
    v_dot2_f32_bf16 v137, s95, v119, v137
    v_dot2_f32_bf16 v136, s96, v120, v136
    v_dot2_f32_bf16 v137, s96, v121, v137
    v_dot2_f32_bf16 v136, s97, v122, v136
    v_dot2_f32_bf16 v137, s97, v123, v137
    v_dot2_f32_bf16 v136, s98, v124, v136
    v_dot2_f32_bf16 v137, s98, v125, v137
    v_dot2_f32_bf16 v136, s99, v126, v136
    v_dot2_f32_bf16 v137, s99, v127, v137
    s_nop 3
    v_mul_f32 v144, 0xbfb8aa3b, v136
    v_mul_f32 v145, 0xbfb8aa3b, v137
    v_exp_f32 v144, v144
    v_exp_f32 v145, v145
    s_nop 0
    v_add_f32 v144, 1.0, v144
    v_add_f32 v145, 1.0, v145
    v_rcp_f32 v144, v144
    v_rcp_f32 v145, v145
    s_nop 0
    v_mul_f32 v144, v136, v144
    v_mul_f32 v145, v137, v145
    ds_add_f32 v138, v144
    ds_add_f32 v138, v145 offset:4
    s_mov_b64 exec, 1
    ds_add_u32 v140, v148
    s_mov_b64 exec, -1
    s_branch SL_edge
SL_next:
    s_add_u32 s28, s28, 12
    s_cmp_lt_u32 s28, 12500
    s_cbranch_scc1 SL_scan
    s_waitcnt lgkmcnt(0)
    s_barrier
    v_lshlrev_b32 v142, 1, v154
    global_load_ushort v128, v142, s[22:23]
    global_load_ushort v0, v142, s[20:21] offset:0
    global_load_ushort v1, v142, s[20:21] offset:128
    global_load_ushort v2, v142, s[20:21] offset:256
    global_load_ushort v3, v142, s[20:21] offset:384
    global_load_ushort v4, v142, s[20:21] offset:512
    global_load_ushort v5, v142, s[20:21] offset:640
    global_load_ushort v6, v142, s[20:21] offset:768
    global_load_ushort v7, v142, s[20:21] offset:896
    global_load_ushort v8, v142, s[20:21] offset:1024
    global_load_ushort v9, v142, s[20:21] offset:1152
    global_load_ushort v10, v142, s[20:21] offset:1280
    global_load_ushort v11, v142, s[20:21] offset:1408
    global_load_ushort v12, v142, s[20:21] offset:1536
    global_load_ushort v13, v142, s[20:21] offset:1664
    global_load_ushort v14, v142, s[20:21] offset:1792
    global_load_ushort v15, v142, s[20:21] offset:1920
    global_load_ushort v16, v142, s[20:21] offset:2048
    global_load_ushort v17, v142, s[20:21] offset:2176
    global_load_ushort v18, v142, s[20:21] offset:2304
    global_load_ushort v19, v142, s[20:21] offset:2432
    global_load_ushort v20, v142, s[20:21] offset:2560
    global_load_ushort v21, v142, s[20:21] offset:2688
    global_load_ushort v22, v142, s[20:21] offset:2816
    global_load_ushort v23, v142, s[20:21] offset:2944
    global_load_ushort v24, v142, s[20:21] offset:3072
    global_load_ushort v25, v142, s[20:21] offset:3200
    global_load_ushort v26, v142, s[20:21] offset:3328
    global_load_ushort v27, v142, s[20:21] offset:3456
    global_load_ushort v28, v142, s[20:21] offset:3584
    global_load_ushort v29, v142, s[20:21] offset:3712
    global_load_ushort v30, v142, s[20:21] offset:3840
    global_load_ushort v31, v142, s[20:21] offset:3968
    v_add_u32 v142, 0x1000, v142
    s_waitcnt vmcnt(0)
    global_load_ushort v32, v142, s[20:21] offset:0
    global_load_ushort v33, v142, s[20:21] offset:128
    global_load_ushort v34, v142, s[20:21] offset:256
    global_load_ushort v35, v142, s[20:21] offset:384
    global_load_ushort v36, v142, s[20:21] offset:512
    global_load_ushort v37, v142, s[20:21] offset:640
    global_load_ushort v38, v142, s[20:21] offset:768
    global_load_ushort v39, v142, s[20:21] offset:896
    global_load_ushort v40, v142, s[20:21] offset:1024
    global_load_ushort v41, v142, s[20:21] offset:1152
    global_load_ushort v42, v142, s[20:21] offset:1280
    global_load_ushort v43, v142, s[20:21] offset:1408
    global_load_ushort v44, v142, s[20:21] offset:1536
    global_load_ushort v45, v142, s[20:21] offset:1664
    global_load_ushort v46, v142, s[20:21] offset:1792
    global_load_ushort v47, v142, s[20:21] offset:1920
    global_load_ushort v48, v142, s[20:21] offset:2048
    global_load_ushort v49, v142, s[20:21] offset:2176
    global_load_ushort v50, v142, s[20:21] offset:2304
    global_load_ushort v51, v142, s[20:21] offset:2432
    global_load_ushort v52, v142, s[20:21] offset:2560
    global_load_ushort v53, v142, s[20:21] offset:2688
    global_load_ushort v54, v142, s[20:21] offset:2816
    global_load_ushort v55, v142, s[20:21] offset:2944
    global_load_ushort v56, v142, s[20:21] offset:3072
    global_load_ushort v57, v142, s[20:21] offset:3200
    global_load_ushort v58, v142, s[20:21] offset:3328
    global_load_ushort v59, v142, s[20:21] offset:3456
    global_load_ushort v60, v142, s[20:21] offset:3584
    global_load_ushort v61, v142, s[20:21] offset:3712
    global_load_ushort v62, v142, s[20:21] offset:3840
    global_load_ushort v63, v142, s[20:21] offset:3968
    v_add_u32 v142, 0x1000, v142
    s_waitcnt vmcnt(0)
    global_load_ushort v64, v142, s[20:21] offset:0
    global_load_ushort v65, v142, s[20:21] offset:128
    global_load_ushort v66, v142, s[20:21] offset:256
    global_load_ushort v67, v142, s[20:21] offset:384
    global_load_ushort v68, v142, s[20:21] offset:512
    global_load_ushort v69, v142, s[20:21] offset:640
    global_load_ushort v70, v142, s[20:21] offset:768
    global_load_ushort v71, v142, s[20:21] offset:896
    global_load_ushort v72, v142, s[20:21] offset:1024
    global_load_ushort v73, v142, s[20:21] offset:1152
    global_load_ushort v74, v142, s[20:21] offset:1280
    global_load_ushort v75, v142, s[20:21] offset:1408
    global_load_ushort v76, v142, s[20:21] offset:1536
    global_load_ushort v77, v142, s[20:21] offset:1664
    global_load_ushort v78, v142, s[20:21] offset:1792
    global_load_ushort v79, v142, s[20:21] offset:1920
    global_load_ushort v80, v142, s[20:21] offset:2048
    global_load_ushort v81, v142, s[20:21] offset:2176
    global_load_ushort v82, v142, s[20:21] offset:2304
    global_load_ushort v83, v142, s[20:21] offset:2432
    global_load_ushort v84, v142, s[20:21] offset:2560
    global_load_ushort v85, v142, s[20:21] offset:2688
    global_load_ushort v86, v142, s[20:21] offset:2816
    global_load_ushort v87, v142, s[20:21] offset:2944
    global_load_ushort v88, v142, s[20:21] offset:3072
    global_load_ushort v89, v142, s[20:21] offset:3200
    global_load_ushort v90, v142, s[20:21] offset:3328
    global_load_ushort v91, v142, s[20:21] offset:3456
    global_load_ushort v92, v142, s[20:21] offset:3584
    global_load_ushort v93, v142, s[20:21] offset:3712
    global_load_ushort v94, v142, s[20:21] offset:3840
    global_load_ushort v95, v142, s[20:21] offset:3968
    v_add_u32 v142, 0x1000, v142
    s_waitcnt vmcnt(0)
    global_load_ushort v96, v142, s[20:21] offset:0
    global_load_ushort v97, v142, s[20:21] offset:128
    global_load_ushort v98, v142, s[20:21] offset:256
    global_load_ushort v99, v142, s[20:21] offset:384
    global_load_ushort v100, v142, s[20:21] offset:512
    global_load_ushort v101, v142, s[20:21] offset:640
    global_load_ushort v102, v142, s[20:21] offset:768
    global_load_ushort v103, v142, s[20:21] offset:896
    global_load_ushort v104, v142, s[20:21] offset:1024
    global_load_ushort v105, v142, s[20:21] offset:1152
    global_load_ushort v106, v142, s[20:21] offset:1280
    global_load_ushort v107, v142, s[20:21] offset:1408
    global_load_ushort v108, v142, s[20:21] offset:1536
    global_load_ushort v109, v142, s[20:21] offset:1664
    global_load_ushort v110, v142, s[20:21] offset:1792
    global_load_ushort v111, v142, s[20:21] offset:1920
    global_load_ushort v112, v142, s[20:21] offset:2048
    global_load_ushort v113, v142, s[20:21] offset:2176
    global_load_ushort v114, v142, s[20:21] offset:2304
    global_load_ushort v115, v142, s[20:21] offset:2432
    global_load_ushort v116, v142, s[20:21] offset:2560
    global_load_ushort v117, v142, s[20:21] offset:2688
    global_load_ushort v118, v142, s[20:21] offset:2816
    global_load_ushort v119, v142, s[20:21] offset:2944
    global_load_ushort v120, v142, s[20:21] offset:3072
    global_load_ushort v121, v142, s[20:21] offset:3200
    global_load_ushort v122, v142, s[20:21] offset:3328
    global_load_ushort v123, v142, s[20:21] offset:3456
    global_load_ushort v124, v142, s[20:21] offset:3584
    global_load_ushort v125, v142, s[20:21] offset:3712
    global_load_ushort v126, v142, s[20:21] offset:3840
    global_load_ushort v127, v142, s[20:21] offset:3968
    v_add_u32 v142, 0x1000, v142
    s_waitcnt vmcnt(0)
    v_lshlrev_b32 v0, 16, v0
    v_lshlrev_b32 v1, 16, v1
    v_lshlrev_b32 v2, 16, v2
    v_lshlrev_b32 v3, 16, v3
    v_lshlrev_b32 v4, 16, v4
    v_lshlrev_b32 v5, 16, v5
    v_lshlrev_b32 v6, 16, v6
    v_lshlrev_b32 v7, 16, v7
    v_lshlrev_b32 v8, 16, v8
    v_lshlrev_b32 v9, 16, v9
    v_lshlrev_b32 v10, 16, v10
    v_lshlrev_b32 v11, 16, v11
    v_lshlrev_b32 v12, 16, v12
    v_lshlrev_b32 v13, 16, v13
    v_lshlrev_b32 v14, 16, v14
    v_lshlrev_b32 v15, 16, v15
    v_lshlrev_b32 v16, 16, v16
    v_lshlrev_b32 v17, 16, v17
    v_lshlrev_b32 v18, 16, v18
    v_lshlrev_b32 v19, 16, v19
    v_lshlrev_b32 v20, 16, v20
    v_lshlrev_b32 v21, 16, v21
    v_lshlrev_b32 v22, 16, v22
    v_lshlrev_b32 v23, 16, v23
    v_lshlrev_b32 v24, 16, v24
    v_lshlrev_b32 v25, 16, v25
    v_lshlrev_b32 v26, 16, v26
    v_lshlrev_b32 v27, 16, v27
    v_lshlrev_b32 v28, 16, v28
    v_lshlrev_b32 v29, 16, v29
    v_lshlrev_b32 v30, 16, v30
    v_lshlrev_b32 v31, 16, v31
    v_lshlrev_b32 v32, 16, v32
    v_lshlrev_b32 v33, 16, v33
    v_lshlrev_b32 v34, 16, v34
    v_lshlrev_b32 v35, 16, v35
    v_lshlrev_b32 v36, 16, v36
    v_lshlrev_b32 v37, 16, v37
    v_lshlrev_b32 v38, 16, v38
    v_lshlrev_b32 v39, 16, v39
    v_lshlrev_b32 v40, 16, v40
    v_lshlrev_b32 v41, 16, v41
    v_lshlrev_b32 v42, 16, v42
    v_lshlrev_b32 v43, 16, v43
    v_lshlrev_b32 v44, 16, v44
    v_lshlrev_b32 v45, 16, v45
    v_lshlrev_b32 v46, 16, v46
    v_lshlrev_b32 v47, 16, v47
    v_lshlrev_b32 v48, 16, v48
    v_lshlrev_b32 v49, 16, v49
    v_lshlrev_b32 v50, 16, v50
    v_lshlrev_b32 v51, 16, v51
    v_lshlrev_b32 v52, 16, v52
    v_lshlrev_b32 v53, 16, v53
    v_lshlrev_b32 v54, 16, v54
    v_lshlrev_b32 v55, 16, v55
    v_lshlrev_b32 v56, 16, v56
    v_lshlrev_b32 v57, 16, v57
    v_lshlrev_b32 v58, 16, v58
    v_lshlrev_b32 v59, 16, v59
    v_lshlrev_b32 v60, 16, v60
    v_lshlrev_b32 v61, 16, v61
    v_lshlrev_b32 v62, 16, v62
    v_lshlrev_b32 v63, 16, v63
    v_lshlrev_b32 v64, 16, v64
    v_lshlrev_b32 v65, 16, v65
    v_lshlrev_b32 v66, 16, v66
    v_lshlrev_b32 v67, 16, v67
    v_lshlrev_b32 v68, 16, v68
    v_lshlrev_b32 v69, 16, v69
    v_lshlrev_b32 v70, 16, v70
    v_lshlrev_b32 v71, 16, v71
    v_lshlrev_b32 v72, 16, v72
    v_lshlrev_b32 v73, 16, v73
    v_lshlrev_b32 v74, 16, v74
    v_lshlrev_b32 v75, 16, v75
    v_lshlrev_b32 v76, 16, v76
    v_lshlrev_b32 v77, 16, v77
    v_lshlrev_b32 v78, 16, v78
    v_lshlrev_b32 v79, 16, v79
    v_lshlrev_b32 v80, 16, v80
    v_lshlrev_b32 v81, 16, v81
    v_lshlrev_b32 v82, 16, v82
    v_lshlrev_b32 v83, 16, v83
    v_lshlrev_b32 v84, 16, v84
    v_lshlrev_b32 v85, 16, v85
    v_lshlrev_b32 v86, 16, v86
    v_lshlrev_b32 v87, 16, v87
    v_lshlrev_b32 v88, 16, v88
    v_lshlrev_b32 v89, 16, v89
    v_lshlrev_b32 v90, 16, v90
    v_lshlrev_b32 v91, 16, v91
    v_lshlrev_b32 v92, 16, v92
    v_lshlrev_b32 v93, 16, v93
    v_lshlrev_b32 v94, 16, v94
    v_lshlrev_b32 v95, 16, v95
    v_lshlrev_b32 v96, 16, v96
    v_lshlrev_b32 v97, 16, v97
    v_lshlrev_b32 v98, 16, v98
    v_lshlrev_b32 v99, 16, v99
    v_lshlrev_b32 v100, 16, v100
    v_lshlrev_b32 v101, 16, v101
    v_lshlrev_b32 v102, 16, v102
    v_lshlrev_b32 v103, 16, v103
    v_lshlrev_b32 v104, 16, v104
    v_lshlrev_b32 v105, 16, v105
    v_lshlrev_b32 v106, 16, v106
    v_lshlrev_b32 v107, 16, v107
    v_lshlrev_b32 v108, 16, v108
    v_lshlrev_b32 v109, 16, v109
    v_lshlrev_b32 v110, 16, v110
    v_lshlrev_b32 v111, 16, v111
    v_lshlrev_b32 v112, 16, v112
    v_lshlrev_b32 v113, 16, v113
    v_lshlrev_b32 v114, 16, v114
    v_lshlrev_b32 v115, 16, v115
    v_lshlrev_b32 v116, 16, v116
    v_lshlrev_b32 v117, 16, v117
    v_lshlrev_b32 v118, 16, v118
    v_lshlrev_b32 v119, 16, v119
    v_lshlrev_b32 v120, 16, v120
    v_lshlrev_b32 v121, 16, v121
    v_lshlrev_b32 v122, 16, v122
    v_lshlrev_b32 v123, 16, v123
    v_lshlrev_b32 v124, 16, v124
    v_lshlrev_b32 v125, 16, v125
    v_lshlrev_b32 v126, 16, v126
    v_lshlrev_b32 v127, 16, v127
    v_lshlrev_b32 v128, 16, v128
    s_mov_b32 s28, s18
SL_node:
    s_cmp_ge_u32 s28, s17
    s_cbranch_scc1 SL_done
    s_lshl_b32 s26, s28, 2
    s_add_u32 s26, s26, 32768
    v_mov_b32 v140, s26
    ds_read_b32 v136, v140
    s_lshl_b32 s26, s28, 9
    v_mov_b32 v140, s26
    s_waitcnt lgkmcnt(0)
    v_cvt_f32_u32 v136, v136
    v_mul_f32 v136, v136, v128
    ds_read_b128 v[144:147], v140 offset:0
    s_waitcnt lgkmcnt(0)
    v_fmac_f32 v136, v144, v0
    v_fmac_f32 v136, v145, v1
    v_fmac_f32 v136, v146, v2
    v_fmac_f32 v136, v147, v3
    ds_read_b128 v[144:147], v140 offset:16
    s_waitcnt lgkmcnt(0)
    v_fmac_f32 v136, v144, v4
    v_fmac_f32 v136, v145, v5
    v_fmac_f32 v136, v146, v6
    v_fmac_f32 v136, v147, v7
    ds_read_b128 v[144:147], v140 offset:32
    s_waitcnt lgkmcnt(0)
    v_fmac_f32 v136, v144, v8
    v_fmac_f32 v136, v145, v9
    v_fmac_f32 v136, v146, v10
    v_fmac_f32 v136, v147, v11
    ds_read_b128 v[144:147], v140 offset:48
    s_waitcnt lgkmcnt(0)
    v_fmac_f32 v136, v144, v12
    v_fmac_f32 v136, v145, v13
    v_fmac_f32 v136, v146, v14
    v_fmac_f32 v136, v147, v15
    ds_read_b128 v[144:147], v140 offset:64
    s_waitcnt lgkmcnt(0)
    v_fmac_f32 v136, v144, v16
    v_fmac_f32 v136, v145, v17
    v_fmac_f32 v136, v146, v18
    v_fmac_f32 v136, v147, v19
    ds_read_b128 v[144:147], v140 offset:80
    s_waitcnt lgkmcnt(0)
    v_fmac_f32 v136, v144, v20
    v_fmac_f32 v136, v145, v21
    v_fmac_f32 v136, v146, v22
    v_fmac_f32 v136, v147, v23
    ds_read_b128 v[144:147], v140 offset:96
    s_waitcnt lgkmcnt(0)
    v_fmac_f32 v136, v144, v24
    v_fmac_f32 v136, v145, v25
    v_fmac_f32 v136, v146, v26
    v_fmac_f32 v136, v147, v27
    ds_read_b128 v[144:147], v140 offset:112
    s_waitcnt lgkmcnt(0)
    v_fmac_f32 v136, v144, v28
    v_fmac_f32 v136, v145, v29
    v_fmac_f32 v136, v146, v30
    v_fmac_f32 v136, v147, v31
    ds_read_b128 v[144:147], v140 offset:128
    s_waitcnt lgkmcnt(0)
    v_fmac_f32 v136, v144, v32
    v_fmac_f32 v136, v145, v33
    v_fmac_f32 v136, v146, v34
    v_fmac_f32 v136, v147, v35
    ds_read_b128 v[144:147], v140 offset:144
    s_waitcnt lgkmcnt(0)
    v_fmac_f32 v136, v144, v36
    v_fmac_f32 v136, v145, v37
    v_fmac_f32 v136, v146, v38
    v_fmac_f32 v136, v147, v39
    ds_read_b128 v[144:147], v140 offset:160
    s_waitcnt lgkmcnt(0)
    v_fmac_f32 v136, v144, v40
    v_fmac_f32 v136, v145, v41
    v_fmac_f32 v136, v146, v42
    v_fmac_f32 v136, v147, v43
    ds_read_b128 v[144:147], v140 offset:176
    s_waitcnt lgkmcnt(0)
    v_fmac_f32 v136, v144, v44
    v_fmac_f32 v136, v145, v45
    v_fmac_f32 v136, v146, v46
    v_fmac_f32 v136, v147, v47
    ds_read_b128 v[144:147], v140 offset:192
    s_waitcnt lgkmcnt(0)
    v_fmac_f32 v136, v144, v48
    v_fmac_f32 v136, v145, v49
    v_fmac_f32 v136, v146, v50
    v_fmac_f32 v136, v147, v51
    ds_read_b128 v[144:147], v140 offset:208
    s_waitcnt lgkmcnt(0)
    v_fmac_f32 v136, v144, v52
    v_fmac_f32 v136, v145, v53
    v_fmac_f32 v136, v146, v54
    v_fmac_f32 v136, v147, v55
    ds_read_b128 v[144:147], v140 offset:224
    s_waitcnt lgkmcnt(0)
    v_fmac_f32 v136, v144, v56
    v_fmac_f32 v136, v145, v57
    v_fmac_f32 v136, v146, v58
    v_fmac_f32 v136, v147, v59
    ds_read_b128 v[144:147], v140 offset:240
    s_waitcnt lgkmcnt(0)
    v_fmac_f32 v136, v144, v60
    v_fmac_f32 v136, v145, v61
    v_fmac_f32 v136, v146, v62
    v_fmac_f32 v136, v147, v63
    ds_read_b128 v[144:147], v140 offset:256
    s_waitcnt lgkmcnt(0)
    v_fmac_f32 v136, v144, v64
    v_fmac_f32 v136, v145, v65
    v_fmac_f32 v136, v146, v66
    v_fmac_f32 v136, v147, v67
    ds_read_b128 v[144:147], v140 offset:272
    s_waitcnt lgkmcnt(0)
    v_fmac_f32 v136, v144, v68
    v_fmac_f32 v136, v145, v69
    v_fmac_f32 v136, v146, v70
    v_fmac_f32 v136, v147, v71
    ds_read_b128 v[144:147], v140 offset:288
    s_waitcnt lgkmcnt(0)
    v_fmac_f32 v136, v144, v72
    v_fmac_f32 v136, v145, v73
    v_fmac_f32 v136, v146, v74
    v_fmac_f32 v136, v147, v75
    ds_read_b128 v[144:147], v140 offset:304
    s_waitcnt lgkmcnt(0)
    v_fmac_f32 v136, v144, v76
    v_fmac_f32 v136, v145, v77
    v_fmac_f32 v136, v146, v78
    v_fmac_f32 v136, v147, v79
    ds_read_b128 v[144:147], v140 offset:320
    s_waitcnt lgkmcnt(0)
    v_fmac_f32 v136, v144, v80
    v_fmac_f32 v136, v145, v81
    v_fmac_f32 v136, v146, v82
    v_fmac_f32 v136, v147, v83
    ds_read_b128 v[144:147], v140 offset:336
    s_waitcnt lgkmcnt(0)
    v_fmac_f32 v136, v144, v84
    v_fmac_f32 v136, v145, v85
    v_fmac_f32 v136, v146, v86
    v_fmac_f32 v136, v147, v87
    ds_read_b128 v[144:147], v140 offset:352
    s_waitcnt lgkmcnt(0)
    v_fmac_f32 v136, v144, v88
    v_fmac_f32 v136, v145, v89
    v_fmac_f32 v136, v146, v90
    v_fmac_f32 v136, v147, v91
    ds_read_b128 v[144:147], v140 offset:368
    s_waitcnt lgkmcnt(0)
    v_fmac_f32 v136, v144, v92
    v_fmac_f32 v136, v145, v93
    v_fmac_f32 v136, v146, v94
    v_fmac_f32 v136, v147, v95
    ds_read_b128 v[144:147], v140 offset:384
    s_waitcnt lgkmcnt(0)
    v_fmac_f32 v136, v144, v96
    v_fmac_f32 v136, v145, v97
    v_fmac_f32 v136, v146, v98
    v_fmac_f32 v136, v147, v99
    ds_read_b128 v[144:147], v140 offset:400
    s_waitcnt lgkmcnt(0)
    v_fmac_f32 v136, v144, v100
    v_fmac_f32 v136, v145, v101
    v_fmac_f32 v136, v146, v102
    v_fmac_f32 v136, v147, v103
    ds_read_b128 v[144:147], v140 offset:416
    s_waitcnt lgkmcnt(0)
    v_fmac_f32 v136, v144, v104
    v_fmac_f32 v136, v145, v105
    v_fmac_f32 v136, v146, v106
    v_fmac_f32 v136, v147, v107
    ds_read_b128 v[144:147], v140 offset:432
    s_waitcnt lgkmcnt(0)
    v_fmac_f32 v136, v144, v108
    v_fmac_f32 v136, v145, v109
    v_fmac_f32 v136, v146, v110
    v_fmac_f32 v136, v147, v111
    ds_read_b128 v[144:147], v140 offset:448
    s_waitcnt lgkmcnt(0)
    v_fmac_f32 v136, v144, v112
    v_fmac_f32 v136, v145, v113
    v_fmac_f32 v136, v146, v114
    v_fmac_f32 v136, v147, v115
    ds_read_b128 v[144:147], v140 offset:464
    s_waitcnt lgkmcnt(0)
    v_fmac_f32 v136, v144, v116
    v_fmac_f32 v136, v145, v117
    v_fmac_f32 v136, v146, v118
    v_fmac_f32 v136, v147, v119
    ds_read_b128 v[144:147], v140 offset:480
    s_waitcnt lgkmcnt(0)
    v_fmac_f32 v136, v144, v120
    v_fmac_f32 v136, v145, v121
    v_fmac_f32 v136, v146, v122
    v_fmac_f32 v136, v147, v123
    ds_read_b128 v[144:147], v140 offset:496
    s_waitcnt lgkmcnt(0)
    v_fmac_f32 v136, v144, v124
    v_fmac_f32 v136, v145, v125
    v_fmac_f32 v136, v146, v126
    v_fmac_f32 v136, v147, v127
    v_cvt_pk_bf16_f32 v136, v136, v136
    s_add_u32 s26, s28, s16
    s_lshl_b32 s26, s26, 7
    v_lshl_add_u32 v142, v154, 1, s26
    global_store_short v142, v136, s[24:25]
    s_add_u32 s28, s28, 12
    s_branch SL_node
SL_done:
    s_endpgm
.section .rodata,"a"
.p2align 6
.amdhsa_kernel standalone__edge_featured_mpnn_mpnn__graph_kernel
  .amdhsa_next_free_vgpr 168
  .amdhsa_next_free_sgpr 102
  .amdhsa_accum_offset 168
  .amdhsa_group_segment_fixed_size 0
  .amdhsa_kernarg_size 88
  .amdhsa_user_sgpr_count 2
  .amdhsa_user_sgpr_kernarg_segment_ptr 1
  .amdhsa_system_sgpr_workgroup_id_x 1
  .amdhsa_float_denorm_mode_32 3
.end_amdhsa_kernel
```
